```python
import torch

def _softmax(x, axis=-1):
    return torch.softmax(x, dim=axis)
def _gelu(x):
    return torch.nn.functional.gelu(x, approximate="tanh")
def _silu(x):
    return torch.nn.functional.silu(x)
def _sigmoid(x):
    return torch.sigmoid(x)
def _layernorm(x, axis=-1, eps=1e-5):
    m = x.mean(dim=axis, keepdim=True)
    v = x.var(dim=axis, keepdim=True, unbiased=False)
    return (x - m) / torch.sqrt(v + eps)
def _scatter_add(tgt, idx, src, axis=0):
    return tgt.clone().index_add_(axis, idx, src)
def _segment_sum(src, seg, n):
    out = torch.zeros((n,) + src.shape[1:], dtype=src.dtype)
    return out.index_add_(0, seg, src)
def _pad(x, pw):
    flat = tuple(v for pair in reversed(pw) for v in pair)
    return torch.nn.functional.pad(x, flat)

kernel_name = 'standalone__edge_featured_mpnn_gatedgcn__graph'

def setup_inputs():

    _w = (lambda a: (lambda t: t.to(torch.bfloat16) if t.is_floating_point() else t)(torch.as_tensor(a)))
    N, deg, D, De = 25000, 16, 128, max(16, 1)
    E = N * deg
    return {
        "x": _w((lambda *s: torch.randn(*s, dtype=torch.bfloat16) * 0.4)(N, D)),
        "e_attr": _w((lambda *s: torch.randn(*s, dtype=torch.bfloat16) * 0.4)(E, De)),
        "src": _w((lambda lo, hi, *s: torch.randint(lo, hi, s))(0, N, E).to(torch.int64)),
        "dst": _w((lambda lo, hi, *s: torch.randint(lo, hi, s))(0, N, E).to(torch.int64)),
        "w_a": _w((lambda *s: torch.randn(*s, dtype=torch.bfloat16) * 0.4)(D, D)),
        "w_b": _w((lambda *s: torch.randn(*s, dtype=torch.bfloat16) * 0.4)(D, D)),
        "w_c": _w((lambda *s: torch.randn(*s, dtype=torch.bfloat16) * 0.4)(De, D)),
        "w_u": _w((lambda *s: torch.randn(*s, dtype=torch.bfloat16) * 0.05)(D, D)),
        "w_v": _w((lambda *s: torch.randn(*s, dtype=torch.bfloat16) * 0.05)(D, D)),
    }

def reference(x, e_attr, src, dst, w_a, w_b, w_c, w_u, w_v):
    N, D = x.shape
    hv = x @ w_v
    g = x[dst] @ w_a + x[src] @ w_b + e_attr @ w_c
    eta = _sigmoid(g)
    denom = _segment_sum(eta, dst, N) + 1e-6
    eta_n = eta / denom[dst]
    agg = _segment_sum(eta_n * hv[src], dst, N)
    z = x @ w_u + agg
    relu_z = torch.where(z > 0, z, 0 * z)
    return x + relu_z
```

```asm
; @launch grid=(256,1,1) block=(512,1,1) lds=163840
.amdgcn_target "amdgcn-amd-amdhsa--gfx950"
.text
.globl standalone__edge_featured_mpnn_gatedgcn__graph_kernel
.p2align 8
.type standalone__edge_featured_mpnn_gatedgcn__graph_kernel,@function
standalone__edge_featured_mpnn_gatedgcn__graph_kernel:
    s_cmp_ge_u32 s2, 256
    s_cbranch_scc1 K2_END
    s_load_dwordx2 s[22:23], s[0:1], 88
    s_load_dwordx4 s[8:11], s[0:1], 16
    s_load_dwordx4 s[4:7], s[0:1], 0
    s_load_dwordx4 s[12:15], s[0:1], 32
    s_load_dwordx4 s[16:19], s[0:1], 56
    s_load_dwordx2 s[20:21], s[0:1], 72
    v_mov_b32 v248, v0
    v_lshrrev_b32 v1, 6, v0
    v_and_b32 v209, 63, v0
    v_readfirstlane_b32 s24, v1
    v_lshlrev_b32 v208, 4, v0
    v_lshlrev_b32 v210, 4, v209
    v_lshlrev_b32 v3, 2, v0
    v_mov_b32 v4, 0
    v_mov_b32 v168, 0
    v_mov_b32 v169, 0
    ds_write_b32 v3, v4 offset:36864
    ds_write_b32 v3, v4 offset:6144
    s_getpc_b64 s[40:41]
    s_lshr_b32 s42, s2, 3
    s_mul_i32 s42, s42, 768
    s_min_u32 s42, s42, 23040
    s_add_u32 s40, s40, s42
    s_addc_u32 s41, s41, 0
    v_lshlrev_b32 v60, 7, v0
    v_mov_b32 v61, s41
    v_add_co_u32 v60, vcc, s40, v60
    s_movk_i32 s40, 6
    s_nop 0
    v_addc_co_u32 v61, vcc, 0, v61, vcc
    v_cmpx_gt_u32 vcc, s40, v0
    s_cbranch_execz K1_NOIPF
    global_load_dword v62, v[60:61], off
    K1_NOIPF:
    s_mov_b64 exec, -1
    s_and_b32 s25, s2, 7
    s_lshl_b32 s25, s25, 5
    s_lshr_b32 s26, s2, 3
    s_add_u32 s25, s25, s26
    s_mul_i32 s3, s25, 12500
    s_add_u32 s100, s3, 12627
    s_add_u32 s3, s3, 127
    s_lshr_b32 s3, s3, 7
    s_lshr_b32 s100, s100, 7
    s_sub_u32 s100, s100, s3
    s_lshl_b32 s100, s100, 8
    s_lshl_b32 s27, s3, 8
    s_mul_i32 s26, s2, 6400
    s_lshl_b32 s44, s24, 14
    s_add_u32 s44, s44, 32768
    s_mov_b32 s41, 0xfb0000
    s_movk_i32 s47, 200
    v_cmp_gt_u32 s[64:65], s47, v0
    s_movk_i32 s47, 3200
    s_waitcnt lgkmcnt(0)
    s_load_dword s79, s[22:23], s41
    s_cmp_ge_u32 s24, 4
    s_cbranch_scc1 K1_LOADER
    s_add_u32 s36, s10, s26
    s_addc_u32 s37, s11, 0
    s_mov_b32 s38, 0x1900
    s_mov_b32 s39, 0x00020000
    s_add_u32 s56, s8, s26
    s_addc_u32 s57, s9, 0
    s_mov_b32 s58, 0x1900
    s_mov_b32 s59, 0x00020000
    s_cmp_ge_u32 s2, 250
    s_cbranch_scc1 K1_WLOAD
    buffer_load_dwordx4 v[64:67], v208, s[36:39], 0 offen
    buffer_load_dwordx4 v[68:71], v208, s[36:39], s47 offen
    buffer_load_dwordx4 v[72:75], v208, s[56:59], 0 offen
    buffer_load_dwordx4 v[76:79], v208, s[56:59], s47 offen
    s_barrier
    s_branch K1_ISSUED
K1_WLOAD:
    s_load_dwordx2 s[56:57], s[0:1], 48
    s_cmp_ge_u32 s2, 252
    s_cselect_b64 s[36:37], s[16:17], s[12:13]
    s_lshl_b32 s47, s24, 13
    s_and_b32 s41, s2, 1
    s_lshl_b32 s41, s41, 7
    v_and_b32 v6, 31, v209
    v_lshrrev_b32 v7, 5, v209
    v_lshlrev_b32 v7, 11, v7
    v_lshl_add_u32 v6, v6, 2, v7
    v_add_u32 v6, s41, v6
    v_add_u32 v7, 0x1000, v6
    s_mov_b32 s38, 32768
    s_waitcnt lgkmcnt(0)
    s_cmp_ge_u32 s2, 254
    s_cselect_b64 s[36:37], s[56:57], s[36:37]
    s_cselect_b32 s38, 4096, s38
    s_cselect_b32 s47, 0, s47
    buffer_load_dword v64, v6, s[36:39], s47 offen offset:0
    buffer_load_dword v65, v6, s[36:39], s47 offen offset:256
    buffer_load_dword v66, v6, s[36:39], s47 offen offset:512
    buffer_load_dword v67, v6, s[36:39], s47 offen offset:768
    buffer_load_dword v68, v6, s[36:39], s47 offen offset:1024
    buffer_load_dword v69, v6, s[36:39], s47 offen offset:1280
    buffer_load_dword v70, v6, s[36:39], s47 offen offset:1536
    buffer_load_dword v71, v6, s[36:39], s47 offen offset:1792
    buffer_load_dword v72, v7, s[36:39], s47 offen offset:0
    buffer_load_dword v73, v7, s[36:39], s47 offen offset:256
    buffer_load_dword v74, v7, s[36:39], s47 offen offset:512
    buffer_load_dword v75, v7, s[36:39], s47 offen offset:768
    buffer_load_dword v76, v7, s[36:39], s47 offen offset:1024
    buffer_load_dword v77, v7, s[36:39], s47 offen offset:1280
    buffer_load_dword v78, v7, s[36:39], s47 offen offset:1536
    buffer_load_dword v79, v7, s[36:39], s47 offen offset:1792
    s_barrier
    s_branch K1_ISSUED
K1_LOADER:
    s_barrier
K1_LD2:
    s_cmp_ge_u32 s24, 6
    s_cselect_b64 s[14:15], s[18:19], s[14:15]
    s_and_b32 s42, s24, 1
    s_lshl_b32 s42, s42, 14
    s_and_b32 s43, s24, 3
    s_lshl_b32 s43, s43, 15
    s_add_u32 s43, s43, 32768
    s_mov_b32 s60, s14
    s_mov_b32 s61, s15
    s_mov_b32 s62, 0x8000
    s_mov_b32 s63, 0x00020000
    s_lshr_b32 s41, s2, 3
    s_lshl_b32 s41, s41, 9
    s_add_u32 s41, s41, s42
    v_lshlrev_b32 v7, 7, v209
    s_mov_b64 exec, 15
    buffer_load_dword v62, v7, s[60:63], s41 offen
    s_mov_b64 exec, -1
    s_add_u32 m0, s43, 8192
    s_add_u32 s41, s42, 0
    buffer_load_dwordx4 v210, s[60:63], s41 offen offset:0 lds
    buffer_load_dwordx4 v210, s[60:63], s41 offen offset:1024 lds
    buffer_load_dwordx4 v210, s[60:63], s41 offen offset:2048 lds
    buffer_load_dwordx4 v210, s[60:63], s41 offen offset:3072 lds
    s_add_u32 m0, s43, 12288
    s_add_u32 s41, s42, 4096
    buffer_load_dwordx4 v210, s[60:63], s41 offen offset:0 lds
    buffer_load_dwordx4 v210, s[60:63], s41 offen offset:1024 lds
    buffer_load_dwordx4 v210, s[60:63], s41 offen offset:2048 lds
    buffer_load_dwordx4 v210, s[60:63], s41 offen offset:3072 lds
    s_add_u32 m0, s43, 24576
    s_add_u32 s41, s42, 8192
    buffer_load_dwordx4 v210, s[60:63], s41 offen offset:0 lds
    buffer_load_dwordx4 v210, s[60:63], s41 offen offset:1024 lds
    buffer_load_dwordx4 v210, s[60:63], s41 offen offset:2048 lds
    buffer_load_dwordx4 v210, s[60:63], s41 offen offset:3072 lds
    s_add_u32 m0, s43, 28672
    s_add_u32 s41, s42, 12288
    buffer_load_dwordx4 v210, s[60:63], s41 offen offset:0 lds
    buffer_load_dwordx4 v210, s[60:63], s41 offen offset:1024 lds
    buffer_load_dwordx4 v210, s[60:63], s41 offen offset:2048 lds
    buffer_load_dwordx4 v210, s[60:63], s41 offen offset:3072 lds
    v_lshrrev_b32 v6, 4, v209
    v_and_b32 v7, 15, v209
    v_xor_b32 v7, v7, v6
    s_and_b32 s40, s24, 1
    s_lshl_b32 s40, s40, 3
    v_xor_b32 v7, s40, v7
    v_lshlrev_b32 v7, 4, v7
    v_lshl_add_u32 v168, v6, 8, v7
    v_xor_b32 v169, 64, v168
    s_and_b32 s36, s24, 3
    s_lshl_b32 s36, s36, 11
    s_and_b32 s37, s24, 2
    s_lshl_b32 s37, s37, 13
    s_lshl_b32 s40, s40, 8
    s_add_u32 s37, s37, s40
    s_add_u32 s37, s37, 32768
    s_add_u32 s32, s4, s27
    s_addc_u32 s33, s5, 0
    s_mov_b32 s34, s100
    s_mov_b32 s35, 0x00020000
    s_add_u32 m0, s37, 0
    s_add_u32 s41, s36, 0
    buffer_load_dwordx4 v168, s[32:35], s41 offen  lds
    buffer_load_dwordx4 v169, s[32:35], s41 offen offset:1024  lds
    s_add_u32 m0, s37, 32768
    s_add_u32 s41, s36, 8192
    buffer_load_dwordx4 v168, s[32:35], s41 offen  lds
    buffer_load_dwordx4 v169, s[32:35], s41 offen offset:1024  lds
    s_add_u32 m0, s37, 65536
    s_add_u32 s41, s36, 16384
    buffer_load_dwordx4 v168, s[32:35], s41 offen  lds
    buffer_load_dwordx4 v169, s[32:35], s41 offen offset:1024  lds
    s_add_u32 m0, s37, 98304
    s_add_u32 s41, s36, 24576
    buffer_load_dwordx4 v168, s[32:35], s41 offen  lds
    buffer_load_dwordx4 v169, s[32:35], s41 offen offset:1024  lds
K1_ISSUED:
    s_add_u32 s28, s22, 0xc80000
    s_addc_u32 s29, s23, 0
    s_mov_b32 s30, 0x380000
    s_mov_b32 s31, 0x00020000
    s_add_u32 s32, s4, s27
    s_addc_u32 s33, s5, 0
    s_mov_b32 s34, s100
    s_mov_b32 s35, 0x00020000
    s_and_b32 s46, s24, 1
    s_cmp_ge_u32 s24, 4
    s_cbranch_scc1 K1_TABLE
    s_setprio 2
    v_mov_b32 v8, 0x7cffffe0
    v_mov_b32 v9, v8
    v_mov_b32 v10, v8
    v_mov_b32 v11, v8
    v_mov_b32 v12, 0
    v_mov_b32 v13, 0
    v_mov_b32 v14, 0
    v_mov_b32 v15, 0
    ds_write_b128 v208, v[8:11] offset:8192
    ds_write_b128 v208, v[8:11] offset:12288
    ds_write_b128 v208, v[8:11] offset:16384
    ds_write_b128 v208, v[8:11] offset:20480
    ds_write_b128 v208, v[12:15] offset:24576
    ds_write_b128 v208, v[12:15] offset:28672
    v_bfe_u32 v40, v0, 0, 1
    v_bfe_u32 v41, v0, 1, 1
    v_lshl_or_b32 v40, v41, 16, v40
    v_mul_u32_u24 v36, 0x3f80, v40
    v_bfe_u32 v40, v0, 2, 1
    v_bfe_u32 v41, v0, 3, 1
    v_lshl_or_b32 v40, v41, 16, v40
    v_mul_u32_u24 v37, 0x3f80, v40
    v_bfe_u32 v40, v0, 4, 1
    v_bfe_u32 v41, v0, 5, 1
    v_lshl_or_b32 v40, v41, 16, v40
    v_mul_u32_u24 v38, 0x3f80, v40
    v_bfe_u32 v40, v0, 6, 1
    v_bfe_u32 v41, v0, 7, 1
    v_lshl_or_b32 v40, v41, 16, v40
    v_mul_u32_u24 v39, 0x3f80, v40
    ds_write_b128 v208, v[36:39] offset:0
    v_bfe_u32 v33, v0, 4, 1
    v_bfe_u32 v34, v0, 5, 1
    v_lshl_or_b32 v33, v33, 1, v34
    v_lshlrev_b32 v33, 1, v33
    v_bfe_u32 v34, v0, 6, 1
    v_bfe_u32 v35, v0, 1, 1
    v_xor_b32 v34, v34, v35
    v_xor_b32 v34, 1, v34
    v_lshlrev_b32 v34, v33, v34
    v_bfe_u32 v40, v34, 0, 1
    v_bfe_u32 v41, v34, 1, 1
    v_lshl_or_b32 v40, v41, 16, v40
    v_mul_u32_u24 v44, 0x3f80, v40
    v_bfe_u32 v40, v34, 2, 1
    v_bfe_u32 v41, v34, 3, 1
    v_lshl_or_b32 v40, v41, 16, v40
    v_mul_u32_u24 v45, 0x3f80, v40
    v_bfe_u32 v40, v34, 4, 1
    v_bfe_u32 v41, v34, 5, 1
    v_lshl_or_b32 v40, v41, 16, v40
    v_mul_u32_u24 v46, 0x3f80, v40
    v_bfe_u32 v40, v34, 6, 1
    v_bfe_u32 v41, v34, 7, 1
    v_lshl_or_b32 v40, v41, 16, v40
    v_mul_u32_u24 v47, 0x3f80, v40
    v_bfe_u32 v33, v0, 2, 2
    v_mul_u32_u24 v33, 0x5555, v33
    v_and_b32 v35, 1, v0
    v_cmp_eq_u32 vcc, 1, v35
    v_and_b32 v35, 0x7f0, v208
    s_nop 0
    v_cndmask_b32 v44, v44, v33, vcc
    ds_write_b128 v35, v[44:47] offset:4096
    v_and_b32 v30, 31, v209
    v_lshrrev_b32 v31, 5, v209
    s_lshr_b32 s66, s24, 1
    v_mov_b32 v34, v30
    v_bfe_u32 v35, v34, 1, 3
    v_xor_b32 v35, v35, v31
    v_lshlrev_b32 v35, 4, v35
    v_lshl_add_u32 v35, v34, 7, v35
    v_add_u32 v216, s44, v35
    v_xor_b32 v217, 32, v216
    v_xor_b32 v218, 64, v216
    v_xor_b32 v219, 96, v216
    v_and_b32 v42, 7, v209
    v_lshlrev_b32 v240, 4, v42
    v_lshlrev_b32 v241, 4, v31
    v_lshlrev_b32 v242, 5, v31
    v_lshrrev_b32 v43, 3, v209
    v_lshlrev_b32 v244, 2, v43
    v_add_u32 v244, 8192, v244
    v_lshlrev_b32 v245, 2, v34
    v_lshlrev_b32 v36, 2, v30
    v_lshl_add_u32 v246, v31, 1, v36
    s_lshl_b32 s41, s46, 7
    v_lshl_add_u32 v247, v31, 10, v36
    v_add_u32 v247, s41, v247
    s_lshl_b32 s47, s46, 15
    s_add_u32 s47, s47, 40960
    v_add_u32 v233, s47, v210
    v_add_u32 v234, 0x10000, v233
    s_mov_b32 s45, 0x00ffffff
    s_mov_b32 s72, 0
    s_mov_b32 s67, 0
    s_add_u32 s48, s22, 0x400
    s_addc_u32 s49, s23, 0
    s_mov_b32 s50, 0xc35c00
    s_mov_b32 s51, 0x00020000
    s_mov_b32 s52, s6
    s_mov_b32 s53, s7
    s_mov_b32 s54, 0xc35000
    s_mov_b32 s55, 0x00020000
    s_add_u32 s68, s20, s27
    s_addc_u32 s69, s21, 0
    s_mov_b32 s70, s100
    s_mov_b32 s71, 0x00020000
    s_mul_i32 s47, s46, 6400000
    s_add_u32 s8, s47, 3072
    s_add_u32 s9, s47, 2048
    s_add_u32 s10, s47, 1024
    s_add_u32 s11, s47, 0
    s_add_u32 s12, s47, 3203072
    s_add_u32 s13, s47, 3202048
    s_add_u32 s14, s47, 3201024
    s_add_u32 s15, s47, 3200000
    s_waitcnt lgkmcnt(0)
    s_mul_i32 s79, s79, 0x9e3779b1
    s_add_u32 s79, s79, 0x7f4a7c15
    s_cmp_ge_u32 s2, 250
    s_cbranch_scc1 K1_WPREP
    v_mov_b32 v4, 1
    v_lshlrev_b32 v6, 8, v0
    s_mov_b32 s47, 175921861
    s_movk_i32 s43, 3125
    v_mov_b32 v5, 127
    s_waitcnt vmcnt(2)
    v_mul_hi_u32 v96, s47, v64
    v_lshlrev_b32 v80, 1, v96
    v_and_b32 v80, -4, v80
    s_mov_b64 exec, s[64:65]
    ds_add_rtn_u32 v88, v80, v4 offset:36864
    s_mov_b64 exec, -1
    v_mad_u32_u24 v28, v96, s43, v5
    v_lshrrev_b32 v28, 7, v28
    v_sub_u32 v64, v64, v28
    v_mul_hi_u32 v97, s47, v65
    v_lshlrev_b32 v81, 1, v97
    v_and_b32 v81, -4, v81
    s_mov_b64 exec, s[64:65]
    ds_add_rtn_u32 v89, v81, v4 offset:36864
    s_mov_b64 exec, -1
    v_mad_u32_u24 v28, v97, s43, v5
    v_lshrrev_b32 v28, 7, v28
    v_sub_u32 v65, v65, v28
    v_mul_hi_u32 v98, s47, v66
    v_lshlrev_b32 v82, 1, v98
    v_and_b32 v82, -4, v82
    s_mov_b64 exec, s[64:65]
    ds_add_rtn_u32 v90, v82, v4 offset:36864
    s_mov_b64 exec, -1
    v_mad_u32_u24 v28, v98, s43, v5
    v_lshrrev_b32 v28, 7, v28
    v_sub_u32 v66, v66, v28
    v_mul_hi_u32 v99, s47, v67
    v_lshlrev_b32 v83, 1, v99
    v_and_b32 v83, -4, v83
    s_mov_b64 exec, s[64:65]
    ds_add_rtn_u32 v91, v83, v4 offset:36864
    s_mov_b64 exec, -1
    v_mad_u32_u24 v28, v99, s43, v5
    v_lshrrev_b32 v28, 7, v28
    v_sub_u32 v67, v67, v28
    v_mul_hi_u32 v100, s47, v68
    v_lshlrev_b32 v84, 1, v100
    v_and_b32 v84, -4, v84
    s_mov_b64 exec, s[64:65]
    ds_add_rtn_u32 v92, v84, v4 offset:36864
    s_mov_b64 exec, -1
    v_mad_u32_u24 v28, v100, s43, v5
    v_lshrrev_b32 v28, 7, v28
    v_sub_u32 v68, v68, v28
    v_mul_hi_u32 v101, s47, v69
    v_lshlrev_b32 v85, 1, v101
    v_and_b32 v85, -4, v85
    s_mov_b64 exec, s[64:65]
    ds_add_rtn_u32 v93, v85, v4 offset:36864
    s_mov_b64 exec, -1
    v_mad_u32_u24 v28, v101, s43, v5
    v_lshrrev_b32 v28, 7, v28
    v_sub_u32 v69, v69, v28
    v_mul_hi_u32 v102, s47, v70
    v_lshlrev_b32 v86, 1, v102
    v_and_b32 v86, -4, v86
    s_mov_b64 exec, s[64:65]
    ds_add_rtn_u32 v94, v86, v4 offset:36864
    s_mov_b64 exec, -1
    v_mad_u32_u24 v28, v102, s43, v5
    v_lshrrev_b32 v28, 7, v28
    v_sub_u32 v70, v70, v28
    v_mul_hi_u32 v103, s47, v71
    v_lshlrev_b32 v87, 1, v103
    v_and_b32 v87, -4, v87
    s_mov_b64 exec, s[64:65]
    ds_add_rtn_u32 v95, v87, v4 offset:36864
    s_mov_b64 exec, -1
    v_mad_u32_u24 v28, v103, s43, v5
    v_lshrrev_b32 v28, 7, v28
    v_sub_u32 v71, v71, v28
    v_lshlrev_b32 v7, 5, v209
    s_waitcnt vmcnt(0) lgkmcnt(0)
    s_mov_b64 exec, 1
    ds_add_u32 v12, v4 offset:7216
    K1_RB0:
    ds_read_b32 v13, v12 offset:7216
    s_waitcnt lgkmcnt(0)
    v_cmp_gt_u32 vcc, 4, v13
    s_cbranch_vccnz K1_RB0
    s_mov_b64 exec, -1
    ds_read_b128 v[32:35], v7 offset:36864
    ds_read_b128 v[36:39], v7 offset:36880
    v_and_b32 v29, 1, v96
    v_lshl_add_u32 v72, v72, 17, v6
    v_lshl_add_u32 v64, v29, 5, v64
    v_add_u32 v64, 0, v64
    v_add_u32 v72, v72, v64
    v_and_b32 v29, 1, v97
    v_lshl_add_u32 v73, v73, 17, v6
    v_lshl_add_u32 v65, v29, 5, v65
    v_add_u32 v65, 64, v65
    v_add_u32 v73, v73, v65
    v_mov_b32 v40, 0
    s_waitcnt lgkmcnt(0)
    v_add_u32 v41, v40, v32
    v_add_u32 v42, v41, v33
    v_add_u32 v43, v42, v34
    v_add_u32 v44, v43, v35
    v_add_u32 v45, v44, v36
    v_add_u32 v46, v45, v37
    v_add_u32 v47, v46, v38
    v_add_u32 v56, v47, v39
    v_mov_b32 v57, v56
    v_and_b32 v29, 1, v98
    v_lshl_add_u32 v74, v74, 17, v6
    v_lshl_add_u32 v66, v29, 5, v66
    v_add_u32 v66, 128, v66
    v_add_u32 v74, v74, v66
    v_add_u32_dpp v57, v57, v57 row_shr:1 row_mask:0xf bank_mask:0xf bound_ctrl:0
    v_and_b32 v29, 1, v99
    v_lshl_add_u32 v75, v75, 17, v6
    v_lshl_add_u32 v67, v29, 5, v67
    v_add_u32 v67, 192, v67
    v_add_u32 v75, v75, v67
    v_add_u32_dpp v57, v57, v57 row_shr:2 row_mask:0xf bank_mask:0xf bound_ctrl:0
    v_and_b32 v29, 1, v100
    v_lshl_add_u32 v76, v76, 17, v6
    v_lshl_add_u32 v68, v29, 5, v68
    v_add_u32 v68, 51200, v68
    v_add_u32 v76, v76, v68
    v_add_u32_dpp v57, v57, v57 row_shr:4 row_mask:0xf bank_mask:0xf bound_ctrl:0
    v_and_b32 v29, 1, v101
    v_lshl_add_u32 v77, v77, 17, v6
    v_lshl_add_u32 v69, v29, 5, v69
    v_add_u32 v69, 51264, v69
    v_add_u32 v77, v77, v69
    v_add_u32_dpp v57, v57, v57 row_shr:8 row_mask:0xf bank_mask:0xf bound_ctrl:0
    v_and_b32 v29, 1, v102
    v_lshl_add_u32 v78, v78, 17, v6
    v_lshl_add_u32 v70, v29, 5, v70
    v_add_u32 v70, 51328, v70
    v_add_u32 v78, v78, v70
    v_add_u32_dpp v57, v57, v57 row_bcast:15 row_mask:0xa bank_mask:0xf
    v_and_b32 v29, 1, v103
    v_lshl_add_u32 v79, v79, 17, v6
    v_lshl_add_u32 v71, v29, 5, v71
    v_add_u32 v71, 51392, v71
    v_add_u32 v79, v79, v71
    v_add_u32_dpp v57, v57, v57 row_bcast:31 row_mask:0xc bank_mask:0xf
    v_sub_u32 v57, v57, v56
    v_lshlrev_b32 v32, 16, v32
    v_add3_u32 v40, v57, v40, v32
    v_lshlrev_b32 v33, 16, v33
    v_add3_u32 v41, v57, v41, v33
    v_lshlrev_b32 v34, 16, v34
    v_add3_u32 v42, v57, v42, v34
    v_lshlrev_b32 v35, 16, v35
    v_add3_u32 v43, v57, v43, v35
    v_lshlrev_b32 v36, 16, v36
    v_add3_u32 v44, v57, v44, v36
    v_lshlrev_b32 v37, 16, v37
    v_add3_u32 v45, v57, v45, v37
    v_lshlrev_b32 v38, 16, v38
    v_add3_u32 v46, v57, v46, v38
    v_lshlrev_b32 v39, 16, v39
    v_add3_u32 v47, v57, v47, v39
    ds_write_b128 v7, v[40:43] offset:38912
    ds_write_b128 v7, v[44:47] offset:38928
    ds_read_u16 v80, v80 offset:38912
    ds_read_u16 v81, v81 offset:38912
    ds_read_u16 v82, v82 offset:38912
    ds_read_u16 v83, v83 offset:38912
    ds_read_u16 v84, v84 offset:38912
    ds_read_u16 v85, v85 offset:38912
    ds_read_u16 v86, v86 offset:38912
    ds_read_u16 v87, v87 offset:38912
    s_waitcnt lgkmcnt(7)
    v_add_lshl_u32 v80, v80, v88, 2
    v_and_b32 v28, 0x1000, v80
    v_mad_u32_u24 v80, v28, 3, v80
    s_waitcnt lgkmcnt(6)
    v_add_lshl_u32 v81, v81, v89, 2
    v_and_b32 v28, 0x1000, v81
    v_mad_u32_u24 v81, v28, 3, v81
    s_waitcnt lgkmcnt(5)
    v_add_lshl_u32 v82, v82, v90, 2
    v_and_b32 v28, 0x1000, v82
    v_mad_u32_u24 v82, v28, 3, v82
    s_waitcnt lgkmcnt(4)
    v_add_lshl_u32 v83, v83, v91, 2
    v_and_b32 v28, 0x1000, v83
    v_mad_u32_u24 v83, v28, 3, v83
    s_waitcnt lgkmcnt(3)
    v_add_lshl_u32 v84, v84, v92, 2
    v_and_b32 v28, 0x1000, v84
    v_mad_u32_u24 v84, v28, 3, v84
    s_waitcnt lgkmcnt(2)
    v_add_lshl_u32 v85, v85, v93, 2
    v_and_b32 v28, 0x1000, v85
    v_mad_u32_u24 v85, v28, 3, v85
    s_waitcnt lgkmcnt(1)
    v_add_lshl_u32 v86, v86, v94, 2
    v_and_b32 v28, 0x1000, v86
    v_mad_u32_u24 v86, v28, 3, v86
    s_waitcnt lgkmcnt(0)
    v_add_lshl_u32 v87, v87, v95, 2
    v_and_b32 v28, 0x1000, v87
    v_mad_u32_u24 v87, v28, 3, v87
    s_mov_b64 exec, s[64:65]
    ds_write_b32 v80, v72 offset:53248
    ds_write_b32 v81, v73 offset:53248
    ds_write_b32 v82, v74 offset:53248
    ds_write_b32 v83, v75 offset:53248
    ds_write_b32 v84, v76 offset:53248
    ds_write_b32 v85, v77 offset:53248
    ds_write_b32 v86, v78 offset:53248
    ds_write_b32 v87, v79 offset:53248
    s_mov_b64 exec, -1
    v_lshlrev_b32 v5, 3, v209
    v_add_u32 v7, 0x4000, v210
    s_waitcnt lgkmcnt(0)
    s_mov_b64 exec, 1
    ds_add_u32 v12, v4 offset:7220
    K1_RB1:
    ds_read_b32 v13, v12 offset:7220
    s_waitcnt lgkmcnt(0)
    v_cmp_gt_u32 vcc, 4, v13
    s_cbranch_vccnz K1_RB1
    s_mov_b64 exec, -1
    s_cmp_lg_u32 s24, 0
    s_cbranch_scc1 K1_NOPUB
    ds_read_b128 v[64:67], v210 offset:53248
    ds_read_b128 v[68:71], v210 offset:54272
    ds_read_b128 v[72:75], v210 offset:55296
    ds_read_b128 v[76:79], v210 offset:56320
    ds_read_b128 v[80:83], v7 offset:53248
    ds_read_b128 v[84:87], v7 offset:54272
    ds_read_b128 v[88:91], v7 offset:55296
    ds_read_b64 v[96:97], v5 offset:38912
    ds_read_b64 v[100:101], v5 offset:39424
    ds_read_b64 v[104:105], v5 offset:39936
    ds_read_b64 v[108:109], v5 offset:40448
    s_add_u32 s47, s26, 4096
    s_waitcnt lgkmcnt(10)
    buffer_store_dwordx4 v[64:67], v210, s[28:31], s26 offen offset:0 sc1
    s_waitcnt lgkmcnt(9)
    buffer_store_dwordx4 v[68:71], v210, s[28:31], s26 offen offset:1024 sc1
    s_waitcnt lgkmcnt(8)
    buffer_store_dwordx4 v[72:75], v210, s[28:31], s26 offen offset:2048 sc1
    s_waitcnt lgkmcnt(7)
    buffer_store_dwordx4 v[76:79], v210, s[28:31], s26 offen offset:3072 sc1
    s_waitcnt lgkmcnt(6)
    buffer_store_dwordx4 v[80:83], v210, s[28:31], s47 offen offset:0 sc1
    s_waitcnt lgkmcnt(5)
    buffer_store_dwordx4 v[84:87], v210, s[28:31], s47 offen offset:1024 sc1
    s_waitcnt lgkmcnt(4)
    s_mov_b64 exec, 0xffff
    buffer_store_dwordx4 v[88:91], v210, s[28:31], s47 offen offset:2048 sc1
    s_mov_b64 exec, -1
    s_lshl_b32 s47, s2, 12
    s_add_u32 s47, s47, 0x1c0000
    s_waitcnt lgkmcnt(0)
    v_mov_b32 v98, v97
    v_mov_b32 v97, s79
    v_mov_b32 v99, s79
    v_mov_b32 v102, v101
    v_mov_b32 v101, s79
    v_mov_b32 v103, s79
    v_mov_b32 v106, v105
    v_mov_b32 v105, s79
    v_mov_b32 v107, s79
    v_mov_b32 v110, v109
    v_mov_b32 v109, s79
    v_mov_b32 v111, s79
    s_waitcnt vmcnt(0)
    buffer_store_dwordx4 v[96:99], v210, s[28:31], s47 offen offset:0 sc1
    buffer_store_dwordx4 v[100:103], v210, s[28:31], s47 offen offset:1024 sc1
    buffer_store_dwordx4 v[104:107], v210, s[28:31], s47 offen offset:2048 sc1
    buffer_store_dwordx4 v[108:111], v210, s[28:31], s47 offen offset:3072 sc1
K1_PUBA:
    v_mov_b32 v12, 0
    v_mov_b32 v13, 4
    s_waitcnt vmcnt(0)
    ds_write_b32 v12, v13 offset:7248
K1_NOPUB:
K1_PUBD:
    s_lshl_b32 s26, s25, 4
    s_add_u32 s26, s26, 0x1c0000
    v_lshlrev_b32 v60, 12, v248
    v_mul_u32_u24 v61, 6400, v248
    v_lshlrev_b32 v38, 1, v248
    v_add_u32 v39, 1, v38
    s_mov_b32 s47, 0x40000
    v_mov_b32 v12, 0
    s_mov_b64 exec, 1
    K1_AW1:
    ds_read_b32 v13, v12 offset:7248
    s_waitcnt lgkmcnt(0)
    v_cmp_gt_u32 vcc, 4, v13
    s_cbranch_vccnz K1_AW1
    s_mov_b64 exec, -1
    v_and_b32 v117, 3, v209
    v_bfe_u32 v118, v209, 3, 2
    v_lshl_or_b32 v117, v118, 2, v117
    v_bfe_u32 v118, v209, 2, 1
    v_lshl_or_b32 v117, v118, 4, v117
    v_lshlrev_b32 v117, v117, 1
    v_lshrrev_b32 v117, v241, v117
    v_bfe_u32 v118, v117, 8, 8
    v_and_b32 v117, 0xff, v117
    v_lshlrev_b32 v117, 4, v117
    v_lshlrev_b32 v118, 4, v118
    ds_read_b128 v[152:155], v117 offset:0
    ds_read_b128 v[156:159], v118 offset:0
    K1_OCHK:
    buffer_load_dwordx4 v[56:59], v60, s[28:31], s26 offen sc1
    s_waitcnt vmcnt(0)
    v_xor_b32 v57, s79, v57
    v_xor_b32 v59, s79, v59
    v_or_b32 v57, v57, v59
    v_cmpx_ne_u32 vcc, 0, v57
    s_cbranch_execz K1_OOK
    s_sleep 2
    s_sub_u32 s47, s47, 1
    s_cbranch_scc0 K1_OCHK
    v_mov_b32 v56, 0
    v_mov_b32 v58, 0
    K1_OOK:
    s_mov_b64 exec, -1
    v_lshrrev_b32 v32, 16, v56
    v_lshrrev_b32 v33, 16, v58
    v_and_b32 v56, 0xffff, v56
    v_and_b32 v58, 0xffff, v58
    v_lshl_add_u32 v34, v56, 2, v61
    v_lshl_add_u32 v35, v58, 2, v61
    v_cmpx_lt_u32 vcc, 0, v32
    buffer_load_dwordx4 v[0:3], v34, s[28:31], 0 offen offset:0 sc1
    v_cmpx_lt_u32 vcc, 4, v32
    buffer_load_dwordx4 v[4:7], v34, s[28:31], 0 offen offset:16 sc1
    v_cmpx_lt_u32 vcc, 8, v32
    buffer_load_dwordx4 v[8:11], v34, s[28:31], 0 offen offset:32 sc1
    v_cmpx_lt_u32 vcc, 12, v32
    buffer_load_dwordx4 v[12:15], v34, s[28:31], 0 offen offset:48 sc1
    s_mov_b64 exec, -1
    v_cmpx_lt_u32 vcc, 0, v33
    buffer_load_dwordx4 v[16:19], v35, s[28:31], 0 offen offset:0 sc1
    v_cmpx_lt_u32 vcc, 4, v33
    buffer_load_dwordx4 v[20:23], v35, s[28:31], 0 offen offset:16 sc1
    v_cmpx_lt_u32 vcc, 8, v33
    buffer_load_dwordx4 v[24:27], v35, s[28:31], 0 offen offset:32 sc1
    v_cmpx_lt_u32 vcc, 12, v33
    buffer_load_dwordx4 v[28:31], v35, s[28:31], 0 offen offset:48 sc1
    s_mov_b64 exec, -1
    v_max_u32 v41, v32, v33
    v_add_u32 v40, v32, v33
    v_cmp_lt_u32 vcc, 16, v41
    s_cbranch_vccz K1_NOBIG
    v_cmpx_lt_u32 vcc, 16, v32
    buffer_load_dwordx4 v[160:163], v34, s[28:31], 0 offen offset:64 sc1
    v_cmpx_lt_u32 vcc, 20, v32
    buffer_load_dwordx4 v[164:167], v34, s[28:31], 0 offen offset:80 sc1
    v_cmpx_lt_u32 vcc, 24, v32
    buffer_load_dwordx4 v[168:171], v34, s[28:31], 0 offen offset:96 sc1
    v_cmpx_lt_u32 vcc, 28, v32
    buffer_load_dwordx4 v[172:175], v34, s[28:31], 0 offen offset:112 sc1
    s_mov_b64 exec, -1
    v_cmpx_lt_u32 vcc, 16, v33
    buffer_load_dwordx4 v[176:179], v35, s[28:31], 0 offen offset:64 sc1
    v_cmpx_lt_u32 vcc, 20, v33
    buffer_load_dwordx4 v[180:183], v35, s[28:31], 0 offen offset:80 sc1
    v_cmpx_lt_u32 vcc, 24, v33
    buffer_load_dwordx4 v[184:187], v35, s[28:31], 0 offen offset:96 sc1
    v_cmpx_lt_u32 vcc, 28, v33
    buffer_load_dwordx4 v[188:191], v35, s[28:31], 0 offen offset:112 sc1
    s_mov_b64 exec, -1
    s_waitcnt vmcnt(0)
    s_nop 2
K1_NOBIG:
    v_mov_b32 v36, v40
    s_nop 1
    v_add_u32_dpp v36, v36, v36 row_shr:1 row_mask:0xf bank_mask:0xf bound_ctrl:0
    s_nop 1
    v_add_u32_dpp v36, v36, v36 row_shr:2 row_mask:0xf bank_mask:0xf bound_ctrl:0
    s_nop 1
    v_add_u32_dpp v36, v36, v36 row_shr:4 row_mask:0xf bank_mask:0xf bound_ctrl:0
    s_nop 1
    v_add_u32_dpp v36, v36, v36 row_shr:8 row_mask:0xf bank_mask:0xf bound_ctrl:0
    s_nop 1
    v_add_u32_dpp v36, v36, v36 row_bcast:15 row_mask:0xa bank_mask:0xf
    s_nop 1
    v_add_u32_dpp v36, v36, v36 row_bcast:31 row_mask:0xc bank_mask:0xf
    v_cmp_lt_u32 vcc, 32, v41
    v_readlane_b32 s73, v36, 63
    v_sub_u32 v36, v36, v40
    v_add_u32 v37, v36, v32
    s_cmp_gt_u32 s73, 640
    s_cselect_b64 vcc, -1, vcc
    s_cbranch_vccz K2_FITS
    s_mov_b32 s73, 0
    s_mov_b32 s67, 1
    v_mov_b32 v32, 0
    v_mov_b32 v33, 0
K2_FITS:
    v_lshl_add_u32 v42, v36, 1, s44
    v_lshl_add_u32 v43, v37, 1, s44
    v_lshl_add_u32 v36, v36, 2, s44
    v_lshl_add_u32 v37, v37, 2, s44
    v_sub_u32 v249, s73, v209
    v_lshl_add_u32 v44, v209, 2, s44
    v_lshl_add_u32 v45, v209, 1, s44
    v_cmpx_lt_u32 vcc, 0, v32
    ds_write_b16 v42, v38 offset:6656
    v_cmpx_lt_u32 vcc, 1, v32
    ds_write_b16 v42, v38 offset:6658
    v_cmpx_lt_u32 vcc, 2, v32
    ds_write_b16 v42, v38 offset:6660
    v_cmpx_lt_u32 vcc, 3, v32
    ds_write_b16 v42, v38 offset:6662
    v_cmpx_lt_u32 vcc, 4, v32
    ds_write_b16 v42, v38 offset:6664
    v_cmpx_lt_u32 vcc, 5, v32
    ds_write_b16 v42, v38 offset:6666
    v_cmpx_lt_u32 vcc, 6, v32
    s_cbranch_execz K2_TD0
    ds_write_b16 v42, v38 offset:6668
    v_cmpx_lt_u32 vcc, 7, v32
    ds_write_b16 v42, v38 offset:6670
    v_cmpx_lt_u32 vcc, 8, v32
    s_cbranch_execz K2_TD0
    ds_write_b16 v42, v38 offset:6672
    v_cmpx_lt_u32 vcc, 9, v32
    ds_write_b16 v42, v38 offset:6674
    v_cmpx_lt_u32 vcc, 10, v32
    s_cbranch_execz K2_TD0
    ds_write_b16 v42, v38 offset:6676
    v_cmpx_lt_u32 vcc, 11, v32
    ds_write_b16 v42, v38 offset:6678
    v_cmpx_lt_u32 vcc, 12, v32
    s_cbranch_execz K2_TD0
    ds_write_b16 v42, v38 offset:6680
    v_cmpx_lt_u32 vcc, 13, v32
    ds_write_b16 v42, v38 offset:6682
    v_cmpx_lt_u32 vcc, 14, v32
    ds_write_b16 v42, v38 offset:6684
    v_cmpx_lt_u32 vcc, 15, v32
    ds_write_b16 v42, v38 offset:6686
    v_cmpx_lt_u32 vcc, 16, v32
    s_cbranch_execz K2_TD0
    ds_write_b16 v42, v38 offset:6688
    v_cmpx_lt_u32 vcc, 17, v32
    ds_write_b16 v42, v38 offset:6690
    v_cmpx_lt_u32 vcc, 18, v32
    ds_write_b16 v42, v38 offset:6692
    v_cmpx_lt_u32 vcc, 19, v32
    ds_write_b16 v42, v38 offset:6694
    v_cmpx_lt_u32 vcc, 20, v32
    s_cbranch_execz K2_TD0
    ds_write_b16 v42, v38 offset:6696
    v_cmpx_lt_u32 vcc, 21, v32
    ds_write_b16 v42, v38 offset:6698
    v_cmpx_lt_u32 vcc, 22, v32
    ds_write_b16 v42, v38 offset:6700
    v_cmpx_lt_u32 vcc, 23, v32
    ds_write_b16 v42, v38 offset:6702
    v_cmpx_lt_u32 vcc, 24, v32
    ds_write_b16 v42, v38 offset:6704
    v_cmpx_lt_u32 vcc, 25, v32
    ds_write_b16 v42, v38 offset:6706
    v_cmpx_lt_u32 vcc, 26, v32
    ds_write_b16 v42, v38 offset:6708
    v_cmpx_lt_u32 vcc, 27, v32
    ds_write_b16 v42, v38 offset:6710
    v_cmpx_lt_u32 vcc, 28, v32
    ds_write_b16 v42, v38 offset:6712
    v_cmpx_lt_u32 vcc, 29, v32
    ds_write_b16 v42, v38 offset:6714
    v_cmpx_lt_u32 vcc, 30, v32
    ds_write_b16 v42, v38 offset:6716
    v_cmpx_lt_u32 vcc, 31, v32
    ds_write_b16 v42, v38 offset:6718
K2_TD0:
    s_mov_b64 exec, -1
    v_cmpx_lt_u32 vcc, 0, v33
    ds_write_b16 v43, v39 offset:6656
    v_cmpx_lt_u32 vcc, 1, v33
    ds_write_b16 v43, v39 offset:6658
    v_cmpx_lt_u32 vcc, 2, v33
    ds_write_b16 v43, v39 offset:6660
    v_cmpx_lt_u32 vcc, 3, v33
    ds_write_b16 v43, v39 offset:6662
    v_cmpx_lt_u32 vcc, 4, v33
    ds_write_b16 v43, v39 offset:6664
    v_cmpx_lt_u32 vcc, 5, v33
    ds_write_b16 v43, v39 offset:6666
    v_cmpx_lt_u32 vcc, 6, v33
    s_cbranch_execz K2_TD1
    ds_write_b16 v43, v39 offset:6668
    v_cmpx_lt_u32 vcc, 7, v33
    ds_write_b16 v43, v39 offset:6670
    v_cmpx_lt_u32 vcc, 8, v33
    s_cbranch_execz K2_TD1
    ds_write_b16 v43, v39 offset:6672
    v_cmpx_lt_u32 vcc, 9, v33
    ds_write_b16 v43, v39 offset:6674
    v_cmpx_lt_u32 vcc, 10, v33
    s_cbranch_execz K2_TD1
    ds_write_b16 v43, v39 offset:6676
    v_cmpx_lt_u32 vcc, 11, v33
    ds_write_b16 v43, v39 offset:6678
    v_cmpx_lt_u32 vcc, 12, v33
    s_cbranch_execz K2_TD1
    ds_write_b16 v43, v39 offset:6680
    v_cmpx_lt_u32 vcc, 13, v33
    ds_write_b16 v43, v39 offset:6682
    v_cmpx_lt_u32 vcc, 14, v33
    ds_write_b16 v43, v39 offset:6684
    v_cmpx_lt_u32 vcc, 15, v33
    ds_write_b16 v43, v39 offset:6686
    v_cmpx_lt_u32 vcc, 16, v33
    s_cbranch_execz K2_TD1
    ds_write_b16 v43, v39 offset:6688
    v_cmpx_lt_u32 vcc, 17, v33
    ds_write_b16 v43, v39 offset:6690
    v_cmpx_lt_u32 vcc, 18, v33
    ds_write_b16 v43, v39 offset:6692
    v_cmpx_lt_u32 vcc, 19, v33
    ds_write_b16 v43, v39 offset:6694
    v_cmpx_lt_u32 vcc, 20, v33
    s_cbranch_execz K2_TD1
    ds_write_b16 v43, v39 offset:6696
    v_cmpx_lt_u32 vcc, 21, v33
    ds_write_b16 v43, v39 offset:6698
    v_cmpx_lt_u32 vcc, 22, v33
    ds_write_b16 v43, v39 offset:6700
    v_cmpx_lt_u32 vcc, 23, v33
    ds_write_b16 v43, v39 offset:6702
    v_cmpx_lt_u32 vcc, 24, v33
    ds_write_b16 v43, v39 offset:6704
    v_cmpx_lt_u32 vcc, 25, v33
    ds_write_b16 v43, v39 offset:6706
    v_cmpx_lt_u32 vcc, 26, v33
    ds_write_b16 v43, v39 offset:6708
    v_cmpx_lt_u32 vcc, 27, v33
    ds_write_b16 v43, v39 offset:6710
    v_cmpx_lt_u32 vcc, 28, v33
    ds_write_b16 v43, v39 offset:6712
    v_cmpx_lt_u32 vcc, 29, v33
    ds_write_b16 v43, v39 offset:6714
    v_cmpx_lt_u32 vcc, 30, v33
    ds_write_b16 v43, v39 offset:6716
    v_cmpx_lt_u32 vcc, 31, v33
    ds_write_b16 v43, v39 offset:6718
K2_TD1:
    s_mov_b64 exec, -1
    ds_read_u16 v106, v45 offset:6656
    ds_read_u16 v107, v45 offset:6784
    ds_read_u16 v108, v45 offset:6912
    ds_read_u16 v109, v45 offset:7040
    ds_read_u16 v110, v45 offset:7168
    ds_read_u16 v111, v45 offset:7296
    ds_read_u16 v112, v45 offset:7424
    ds_read_u16 v113, v45 offset:7552
    ds_read_u16 v114, v45 offset:7680
    ds_read_u16 v115, v45 offset:7808
    s_waitcnt vmcnt(4)
    v_cmpx_lt_u32 vcc, 0, v32
    ds_write_b32 v36, v0 offset:4096
    v_cmpx_lt_u32 vcc, 1, v32
    ds_write_b32 v36, v1 offset:4100
    v_cmpx_lt_u32 vcc, 2, v32
    ds_write_b32 v36, v2 offset:4104
    v_cmpx_lt_u32 vcc, 3, v32
    ds_write_b32 v36, v3 offset:4108
    v_cmpx_lt_u32 vcc, 4, v32
    ds_write_b32 v36, v4 offset:4112
    v_cmpx_lt_u32 vcc, 5, v32
    ds_write_b32 v36, v5 offset:4116
    v_cmpx_lt_u32 vcc, 6, v32
    s_cbranch_execz K2_CD0
    ds_write_b32 v36, v6 offset:4120
    v_cmpx_lt_u32 vcc, 7, v32
    ds_write_b32 v36, v7 offset:4124
    v_cmpx_lt_u32 vcc, 8, v32
    s_cbranch_execz K2_CD0
    ds_write_b32 v36, v8 offset:4128
    v_cmpx_lt_u32 vcc, 9, v32
    ds_write_b32 v36, v9 offset:4132
    v_cmpx_lt_u32 vcc, 10, v32
    s_cbranch_execz K2_CD0
    ds_write_b32 v36, v10 offset:4136
    v_cmpx_lt_u32 vcc, 11, v32
    ds_write_b32 v36, v11 offset:4140
    v_cmpx_lt_u32 vcc, 12, v32
    s_cbranch_execz K2_CD0
    ds_write_b32 v36, v12 offset:4144
    v_cmpx_lt_u32 vcc, 13, v32
    ds_write_b32 v36, v13 offset:4148
    v_cmpx_lt_u32 vcc, 14, v32
    ds_write_b32 v36, v14 offset:4152
    v_cmpx_lt_u32 vcc, 15, v32
    ds_write_b32 v36, v15 offset:4156
    v_cmpx_lt_u32 vcc, 16, v32
    s_cbranch_execz K2_CD0
    ds_write_b32 v36, v160 offset:4160
    v_cmpx_lt_u32 vcc, 17, v32
    ds_write_b32 v36, v161 offset:4164
    v_cmpx_lt_u32 vcc, 18, v32
    ds_write_b32 v36, v162 offset:4168
    v_cmpx_lt_u32 vcc, 19, v32
    ds_write_b32 v36, v163 offset:4172
    v_cmpx_lt_u32 vcc, 20, v32
    s_cbranch_execz K2_CD0
    ds_write_b32 v36, v164 offset:4176
    v_cmpx_lt_u32 vcc, 21, v32
    ds_write_b32 v36, v165 offset:4180
    v_cmpx_lt_u32 vcc, 22, v32
    ds_write_b32 v36, v166 offset:4184
    v_cmpx_lt_u32 vcc, 23, v32
    ds_write_b32 v36, v167 offset:4188
    v_cmpx_lt_u32 vcc, 24, v32
    ds_write_b32 v36, v168 offset:4192
    v_cmpx_lt_u32 vcc, 25, v32
    ds_write_b32 v36, v169 offset:4196
    v_cmpx_lt_u32 vcc, 26, v32
    ds_write_b32 v36, v170 offset:4200
    v_cmpx_lt_u32 vcc, 27, v32
    ds_write_b32 v36, v171 offset:4204
    v_cmpx_lt_u32 vcc, 28, v32
    ds_write_b32 v36, v172 offset:4208
    v_cmpx_lt_u32 vcc, 29, v32
    ds_write_b32 v36, v173 offset:4212
    v_cmpx_lt_u32 vcc, 30, v32
    ds_write_b32 v36, v174 offset:4216
    v_cmpx_lt_u32 vcc, 31, v32
    ds_write_b32 v36, v175 offset:4220
K2_CD0:
    s_mov_b64 exec, -1
    s_waitcnt vmcnt(0)
    v_cmpx_lt_u32 vcc, 0, v33
    ds_write_b32 v37, v16 offset:4096
    v_cmpx_lt_u32 vcc, 1, v33
    ds_write_b32 v37, v17 offset:4100
    v_cmpx_lt_u32 vcc, 2, v33
    ds_write_b32 v37, v18 offset:4104
    v_cmpx_lt_u32 vcc, 3, v33
    ds_write_b32 v37, v19 offset:4108
    v_cmpx_lt_u32 vcc, 4, v33
    ds_write_b32 v37, v20 offset:4112
    v_cmpx_lt_u32 vcc, 5, v33
    ds_write_b32 v37, v21 offset:4116
    v_cmpx_lt_u32 vcc, 6, v33
    s_cbranch_execz K2_CD1
    ds_write_b32 v37, v22 offset:4120
    v_cmpx_lt_u32 vcc, 7, v33
    ds_write_b32 v37, v23 offset:4124
    v_cmpx_lt_u32 vcc, 8, v33
    s_cbranch_execz K2_CD1
    ds_write_b32 v37, v24 offset:4128
    v_cmpx_lt_u32 vcc, 9, v33
    ds_write_b32 v37, v25 offset:4132
    v_cmpx_lt_u32 vcc, 10, v33
    s_cbranch_execz K2_CD1
    ds_write_b32 v37, v26 offset:4136
    v_cmpx_lt_u32 vcc, 11, v33
    ds_write_b32 v37, v27 offset:4140
    v_cmpx_lt_u32 vcc, 12, v33
    s_cbranch_execz K2_CD1
    ds_write_b32 v37, v28 offset:4144
    v_cmpx_lt_u32 vcc, 13, v33
    ds_write_b32 v37, v29 offset:4148
    v_cmpx_lt_u32 vcc, 14, v33
    ds_write_b32 v37, v30 offset:4152
    v_cmpx_lt_u32 vcc, 15, v33
    ds_write_b32 v37, v31 offset:4156
    v_cmpx_lt_u32 vcc, 16, v33
    s_cbranch_execz K2_CD1
    ds_write_b32 v37, v176 offset:4160
    v_cmpx_lt_u32 vcc, 17, v33
    ds_write_b32 v37, v177 offset:4164
    v_cmpx_lt_u32 vcc, 18, v33
    ds_write_b32 v37, v178 offset:4168
    v_cmpx_lt_u32 vcc, 19, v33
    ds_write_b32 v37, v179 offset:4172
    v_cmpx_lt_u32 vcc, 20, v33
    s_cbranch_execz K2_CD1
    ds_write_b32 v37, v180 offset:4176
    v_cmpx_lt_u32 vcc, 21, v33
    ds_write_b32 v37, v181 offset:4180
    v_cmpx_lt_u32 vcc, 22, v33
    ds_write_b32 v37, v182 offset:4184
    v_cmpx_lt_u32 vcc, 23, v33
    ds_write_b32 v37, v183 offset:4188
    v_cmpx_lt_u32 vcc, 24, v33
    ds_write_b32 v37, v184 offset:4192
    v_cmpx_lt_u32 vcc, 25, v33
    ds_write_b32 v37, v185 offset:4196
    v_cmpx_lt_u32 vcc, 26, v33
    ds_write_b32 v37, v186 offset:4200
    v_cmpx_lt_u32 vcc, 27, v33
    ds_write_b32 v37, v187 offset:4204
    v_cmpx_lt_u32 vcc, 28, v33
    ds_write_b32 v37, v188 offset:4208
    v_cmpx_lt_u32 vcc, 29, v33
    ds_write_b32 v37, v189 offset:4212
    v_cmpx_lt_u32 vcc, 30, v33
    ds_write_b32 v37, v190 offset:4216
    v_cmpx_lt_u32 vcc, 31, v33
    ds_write_b32 v37, v191 offset:4220
K2_CD1:
    s_mov_b64 exec, -1
    ds_read_b32 v96, v44 offset:4096
    ds_read_b32 v97, v44 offset:4352
    ds_read_b32 v98, v44 offset:4608
    ds_read_b32 v99, v44 offset:4864
    ds_read_b32 v100, v44 offset:5120
    ds_read_b32 v101, v44 offset:5376
    ds_read_b32 v102, v44 offset:5632
    ds_read_b32 v103, v44 offset:5888
    ds_read_b32 v104, v44 offset:6144
    ds_read_b32 v105, v44 offset:6400
    v_mov_b32 v116, 1
    s_mov_b32 s43, 10736
    s_movk_i32 s47, 25600
    v_mov_b32 v64, 0
    v_mov_b32 v65, 0
    v_mov_b32 v66, 0
    v_mov_b32 v67, 0
    v_mov_b32 v68, 0
    v_mov_b32 v69, 0
    v_mov_b32 v70, 0
    v_mov_b32 v71, 0
    v_mov_b32 v72, 0
    v_mov_b32 v73, 0
    s_waitcnt lgkmcnt(0)
    v_cmpx_lt_i32 vcc, 0, v249
    v_mul_hi_u32 v64, s43, v96
    v_bfe_u32 v64, v64, 8, 5
    v_and_or_b32 v64, v96, 32, v64
    v_and_b32 v117, 1, v106
    v_lshl_or_b32 v64, v117, 6, v64
    v_lshlrev_b32 v64, 2, v64
    ds_add_rtn_u32 v74, v64, v116 offset:6144
    v_sub_u32 v117, v106, v117
    v_bfe_u32 v118, v96, 6, 11
    v_lshlrev_b32 v118, 5, v118
    v_mad_u32_u24 v117, v117, s47, v118
    v_and_b32 v118, 31, v96
    v_lshl_or_b32 v84, v118, 26, v117
    v_lshrrev_b32 v106, 17, v96
    v_cmpx_lt_i32 vcc, 64, v249
    s_cbranch_execz K2_HD
    v_mul_hi_u32 v65, s43, v97
    v_bfe_u32 v65, v65, 8, 5
    v_and_or_b32 v65, v97, 32, v65
    v_and_b32 v117, 1, v107
    v_lshl_or_b32 v65, v117, 6, v65
    v_lshlrev_b32 v65, 2, v65
    ds_add_rtn_u32 v75, v65, v116 offset:6144
    v_sub_u32 v117, v107, v117
    v_bfe_u32 v118, v97, 6, 11
    v_lshlrev_b32 v118, 5, v118
    v_mad_u32_u24 v117, v117, s47, v118
    v_and_b32 v118, 31, v97
    v_lshl_or_b32 v85, v118, 26, v117
    v_lshrrev_b32 v107, 17, v97
    v_cmpx_lt_i32 vcc, 0x80, v249
    v_mul_hi_u32 v66, s43, v98
    v_bfe_u32 v66, v66, 8, 5
    v_and_or_b32 v66, v98, 32, v66
    v_and_b32 v117, 1, v108
    v_lshl_or_b32 v66, v117, 6, v66
    v_lshlrev_b32 v66, 2, v66
    ds_add_rtn_u32 v76, v66, v116 offset:6144
    v_sub_u32 v117, v108, v117
    v_bfe_u32 v118, v98, 6, 11
    v_lshlrev_b32 v118, 5, v118
    v_mad_u32_u24 v117, v117, s47, v118
    v_and_b32 v118, 31, v98
    v_lshl_or_b32 v86, v118, 26, v117
    v_lshrrev_b32 v108, 17, v98
    v_cmpx_lt_i32 vcc, 0xc0, v249
    v_mul_hi_u32 v67, s43, v99
    v_bfe_u32 v67, v67, 8, 5
    v_and_or_b32 v67, v99, 32, v67
    v_and_b32 v117, 1, v109
    v_lshl_or_b32 v67, v117, 6, v67
    v_lshlrev_b32 v67, 2, v67
    ds_add_rtn_u32 v77, v67, v116 offset:6144
    v_sub_u32 v117, v109, v117
    v_bfe_u32 v118, v99, 6, 11
    v_lshlrev_b32 v118, 5, v118
    v_mad_u32_u24 v117, v117, s47, v118
    v_and_b32 v118, 31, v99
    v_lshl_or_b32 v87, v118, 26, v117
    v_lshrrev_b32 v109, 17, v99
    v_cmpx_lt_i32 vcc, 0x100, v249
    v_mul_hi_u32 v68, s43, v100
    v_bfe_u32 v68, v68, 8, 5
    v_and_or_b32 v68, v100, 32, v68
    v_and_b32 v117, 1, v110
    v_lshl_or_b32 v68, v117, 6, v68
    v_lshlrev_b32 v68, 2, v68
    ds_add_rtn_u32 v78, v68, v116 offset:6144
    v_sub_u32 v117, v110, v117
    v_bfe_u32 v118, v100, 6, 11
    v_lshlrev_b32 v118, 5, v118
    v_mad_u32_u24 v117, v117, s47, v118
    v_and_b32 v118, 31, v100
    v_lshl_or_b32 v88, v118, 26, v117
    v_lshrrev_b32 v110, 17, v100
    v_cmpx_lt_i32 vcc, 0x140, v249
    v_mul_hi_u32 v69, s43, v101
    v_bfe_u32 v69, v69, 8, 5
    v_and_or_b32 v69, v101, 32, v69
    v_and_b32 v117, 1, v111
    v_lshl_or_b32 v69, v117, 6, v69
    v_lshlrev_b32 v69, 2, v69
    ds_add_rtn_u32 v79, v69, v116 offset:6144
    v_sub_u32 v117, v111, v117
    v_bfe_u32 v118, v101, 6, 11
    v_lshlrev_b32 v118, 5, v118
    v_mad_u32_u24 v117, v117, s47, v118
    v_and_b32 v118, 31, v101
    v_lshl_or_b32 v89, v118, 26, v117
    v_lshrrev_b32 v111, 17, v101
    v_cmpx_lt_i32 vcc, 0x180, v249
    s_cbranch_execz K2_HD
    v_mul_hi_u32 v70, s43, v102
    v_bfe_u32 v70, v70, 8, 5
    v_and_or_b32 v70, v102, 32, v70
    v_and_b32 v117, 1, v112
    v_lshl_or_b32 v70, v117, 6, v70
    v_lshlrev_b32 v70, 2, v70
    ds_add_rtn_u32 v80, v70, v116 offset:6144
    v_sub_u32 v117, v112, v117
    v_bfe_u32 v118, v102, 6, 11
    v_lshlrev_b32 v118, 5, v118
    v_mad_u32_u24 v117, v117, s47, v118
    v_and_b32 v118, 31, v102
    v_lshl_or_b32 v90, v118, 26, v117
    v_lshrrev_b32 v112, 17, v102
    v_cmpx_lt_i32 vcc, 0x1c0, v249
    s_cbranch_execz K2_HD
    v_mul_hi_u32 v71, s43, v103
    v_bfe_u32 v71, v71, 8, 5
    v_and_or_b32 v71, v103, 32, v71
    v_and_b32 v117, 1, v113
    v_lshl_or_b32 v71, v117, 6, v71
    v_lshlrev_b32 v71, 2, v71
    ds_add_rtn_u32 v81, v71, v116 offset:6144
    v_sub_u32 v117, v113, v117
    v_bfe_u32 v118, v103, 6, 11
    v_lshlrev_b32 v118, 5, v118
    v_mad_u32_u24 v117, v117, s47, v118
    v_and_b32 v118, 31, v103
    v_lshl_or_b32 v91, v118, 26, v117
    v_lshrrev_b32 v113, 17, v103
    v_cmpx_lt_i32 vcc, 0x200, v249
    s_cbranch_execz K2_HD
    v_mul_hi_u32 v72, s43, v104
    v_bfe_u32 v72, v72, 8, 5
    v_and_or_b32 v72, v104, 32, v72
    v_and_b32 v117, 1, v114
    v_lshl_or_b32 v72, v117, 6, v72
    v_lshlrev_b32 v72, 2, v72
    ds_add_rtn_u32 v82, v72, v116 offset:6144
    v_sub_u32 v117, v114, v117
    v_bfe_u32 v118, v104, 6, 11
    v_lshlrev_b32 v118, 5, v118
    v_mad_u32_u24 v117, v117, s47, v118
    v_and_b32 v118, 31, v104
    v_lshl_or_b32 v92, v118, 26, v117
    v_lshrrev_b32 v114, 17, v104
    v_cmpx_lt_i32 vcc, 0x240, v249
    s_cbranch_execz K2_HD
    v_mul_hi_u32 v73, s43, v105
    v_bfe_u32 v73, v73, 8, 5
    v_and_or_b32 v73, v105, 32, v73
    v_and_b32 v117, 1, v115
    v_lshl_or_b32 v73, v117, 6, v73
    v_lshlrev_b32 v73, 2, v73
    ds_add_rtn_u32 v83, v73, v116 offset:6144
    v_sub_u32 v117, v115, v117
    v_bfe_u32 v118, v105, 6, 11
    v_lshlrev_b32 v118, 5, v118
    v_mad_u32_u24 v117, v117, s47, v118
    v_and_b32 v118, 31, v105
    v_lshl_or_b32 v93, v118, 26, v117
    v_lshrrev_b32 v115, 17, v105
    K2_HD:
    s_mov_b64 exec, -1
    v_mov_b32 v117, 0
    s_mov_b32 exec_lo, s67
    s_mov_b32 exec_hi, 0
    ds_write_b32 v117, v116 offset:7168
    s_mov_b64 exec, -1
    s_branch K1_JOIN
K1_TABLE:
    v_and_b32 v30, 31, v209
    v_lshrrev_b32 v31, 5, v209
    v_and_b32 v42, 7, v209
    v_lshrrev_b32 v43, 3, v209
    v_and_b32 v37, 15, v30
    v_lshrrev_b32 v36, 4, v30
    v_lshlrev_b32 v36, 14, v36
    v_lshl_add_u32 v38, v37, 8, v36
    v_xor_b32 v37, v37, v31
    v_lshl_add_u32 v38, v37, 4, v38
    v_add_u32 v224, 32768, v38
    v_xor_b32 v225, 32, v224
    v_xor_b32 v226, 64, v224
    v_xor_b32 v227, 96, v224
    v_xor_b32 v228, 128, v224
    v_xor_b32 v229, 160, v224
    v_xor_b32 v230, 192, v224
    v_xor_b32 v231, 224, v224
    v_mov_b32 v237, 0xbfb8aa3b
    s_add_u32 s47, s44, 4096
    v_xor_b32 v37, v42, v31
    v_lshlrev_b32 v37, 4, v37
    v_lshl_add_u32 v37, v30, 7, v37
    v_add_u32 v212, s47, v37
    v_xor_b32 v213, 32, v212
    v_xor_b32 v214, 64, v212
    v_xor_b32 v215, 96, v212
    v_xor_b32 v37, v42, v43
    v_lshlrev_b32 v37, 4, v37
    v_lshl_add_u32 v37, v43, 7, v37
    v_add_u32 v232, s47, v37
    s_and_b32 s40, s24, 2
    s_lshl_b32 s40, s40, 6
    s_add_u32 s40, s40, 40960
    v_lshlrev_b32 v238, 11, v31
    v_lshl_add_u32 v238, v30, 2, v238
    v_add_u32 v238, s40, v238
    v_add_u32 v235, 0x10000, v238
    s_mov_b32 s42, 0x05040100
    s_cmp_eq_u32 s46, 1
    s_cselect_b32 s42, 0x07060302, s42
    s_lshr_b32 s47, s27, 1
    s_and_b32 s41, s24, 3
    s_mul_i32 s41, s41, 3200000
    s_add_u32 s47, s47, s41
    s_add_u32 s47, s47, 0x1000
    s_lshr_b32 s41, s100, 1
    s_add_u32 s60, s22, s47
    s_addc_u32 s61, s23, 0
    s_mov_b32 s62, s41
    s_mov_b32 s63, 0x00020000
    s_waitcnt vmcnt(8) lgkmcnt(0)
    s_mul_i32 s79, s79, 0x9e3779b1
    s_add_u32 s79, s79, 0x7f4a7c15
    s_mov_b64 exec, 1
    v_mov_b32 v170, 0
    v_mov_b32 v171, 1
    ds_add_u32 v170, v171 offset:7232
    K1_AW2:
    ds_read_b32 v171, v170 offset:7232
    s_waitcnt lgkmcnt(0)
    v_cmp_gt_u32 vcc, 4, v171
    s_cbranch_vccnz K1_AW2
    s_mov_b64 exec, -1
    ds_read2st64_b32 v[64:65], v238 offset0:0 offset1:1
    ds_read2st64_b32 v[66:67], v238 offset0:2 offset1:3
    ds_read2st64_b32 v[68:69], v238 offset0:4 offset1:5
    ds_read2st64_b32 v[70:71], v238 offset0:6 offset1:7
    ds_read2st64_b32 v[72:73], v238 offset0:16 offset1:17
    ds_read2st64_b32 v[74:75], v238 offset0:18 offset1:19
    ds_read2st64_b32 v[76:77], v238 offset0:20 offset1:21
    ds_read2st64_b32 v[78:79], v238 offset0:22 offset1:23
    ds_read2st64_b32 v[80:81], v238 offset0:64 offset1:65
    ds_read2st64_b32 v[82:83], v238 offset0:66 offset1:67
    ds_read2st64_b32 v[84:85], v238 offset0:68 offset1:69
    ds_read2st64_b32 v[86:87], v238 offset0:70 offset1:71
    ds_read2st64_b32 v[88:89], v238 offset0:80 offset1:81
    ds_read2st64_b32 v[90:91], v238 offset0:82 offset1:83
    ds_read2st64_b32 v[92:93], v238 offset0:84 offset1:85
    ds_read2st64_b32 v[94:95], v238 offset0:86 offset1:87
    ds_read2st64_b32 v[96:97], v238 offset0:128 offset1:129
    ds_read2st64_b32 v[98:99], v238 offset0:130 offset1:131
    ds_read2st64_b32 v[100:101], v238 offset0:132 offset1:133
    ds_read2st64_b32 v[102:103], v238 offset0:134 offset1:135
    ds_read2st64_b32 v[104:105], v238 offset0:144 offset1:145
    ds_read2st64_b32 v[106:107], v238 offset0:146 offset1:147
    ds_read2st64_b32 v[108:109], v238 offset0:148 offset1:149
    ds_read2st64_b32 v[110:111], v238 offset0:150 offset1:151
    ds_read2st64_b32 v[112:113], v238 offset0:192 offset1:193
    ds_read2st64_b32 v[114:115], v238 offset0:194 offset1:195
    ds_read2st64_b32 v[116:117], v238 offset0:196 offset1:197
    ds_read2st64_b32 v[118:119], v238 offset0:198 offset1:199
    ds_read2st64_b32 v[120:121], v238 offset0:208 offset1:209
    ds_read2st64_b32 v[122:123], v238 offset0:210 offset1:211
    ds_read2st64_b32 v[124:125], v238 offset0:212 offset1:213
    ds_read2st64_b32 v[126:127], v238 offset0:214 offset1:215
    s_waitcnt lgkmcnt(15)
    v_perm_b32 v0, v65, v64, s42
    v_perm_b32 v1, v67, v66, s42
    v_perm_b32 v2, v69, v68, s42
    v_perm_b32 v3, v71, v70, s42
    v_perm_b32 v4, v73, v72, s42
    v_perm_b32 v5, v75, v74, s42
    v_perm_b32 v6, v77, v76, s42
    v_perm_b32 v7, v79, v78, s42
    v_perm_b32 v8, v81, v80, s42
    v_perm_b32 v9, v83, v82, s42
    v_perm_b32 v10, v85, v84, s42
    v_perm_b32 v11, v87, v86, s42
    v_perm_b32 v12, v89, v88, s42
    v_perm_b32 v13, v91, v90, s42
    v_perm_b32 v14, v93, v92, s42
    v_perm_b32 v15, v95, v94, s42
    s_waitcnt lgkmcnt(0)
    ds_read2st64_b32 v[64:65], v235 offset0:0 offset1:1
    ds_read2st64_b32 v[66:67], v235 offset0:2 offset1:3
    ds_read2st64_b32 v[68:69], v235 offset0:4 offset1:5
    ds_read2st64_b32 v[70:71], v235 offset0:6 offset1:7
    ds_read2st64_b32 v[72:73], v235 offset0:16 offset1:17
    ds_read2st64_b32 v[74:75], v235 offset0:18 offset1:19
    ds_read2st64_b32 v[76:77], v235 offset0:20 offset1:21
    ds_read2st64_b32 v[78:79], v235 offset0:22 offset1:23
    ds_read2st64_b32 v[80:81], v235 offset0:64 offset1:65
    ds_read2st64_b32 v[82:83], v235 offset0:66 offset1:67
    ds_read2st64_b32 v[84:85], v235 offset0:68 offset1:69
    ds_read2st64_b32 v[86:87], v235 offset0:70 offset1:71
    ds_read2st64_b32 v[88:89], v235 offset0:80 offset1:81
    ds_read2st64_b32 v[90:91], v235 offset0:82 offset1:83
    ds_read2st64_b32 v[92:93], v235 offset0:84 offset1:85
    ds_read2st64_b32 v[94:95], v235 offset0:86 offset1:87
    v_perm_b32 v16, v97, v96, s42
    v_perm_b32 v17, v99, v98, s42
    v_perm_b32 v18, v101, v100, s42
    v_perm_b32 v19, v103, v102, s42
    v_perm_b32 v20, v105, v104, s42
    v_perm_b32 v21, v107, v106, s42
    v_perm_b32 v22, v109, v108, s42
    v_perm_b32 v23, v111, v110, s42
    v_perm_b32 v24, v113, v112, s42
    v_perm_b32 v25, v115, v114, s42
    v_perm_b32 v26, v117, v116, s42
    v_perm_b32 v27, v119, v118, s42
    v_perm_b32 v28, v121, v120, s42
    v_perm_b32 v29, v123, v122, s42
    v_perm_b32 v30, v125, v124, s42
    v_perm_b32 v31, v127, v126, s42
    ds_read2st64_b32 v[96:97], v235 offset0:128 offset1:129
    ds_read2st64_b32 v[98:99], v235 offset0:130 offset1:131
    ds_read2st64_b32 v[100:101], v235 offset0:132 offset1:133
    ds_read2st64_b32 v[102:103], v235 offset0:134 offset1:135
    ds_read2st64_b32 v[104:105], v235 offset0:144 offset1:145
    ds_read2st64_b32 v[106:107], v235 offset0:146 offset1:147
    ds_read2st64_b32 v[108:109], v235 offset0:148 offset1:149
    ds_read2st64_b32 v[110:111], v235 offset0:150 offset1:151
    ds_read2st64_b32 v[112:113], v235 offset0:192 offset1:193
    ds_read2st64_b32 v[114:115], v235 offset0:194 offset1:195
    ds_read2st64_b32 v[116:117], v235 offset0:196 offset1:197
    ds_read2st64_b32 v[118:119], v235 offset0:198 offset1:199
    ds_read2st64_b32 v[120:121], v235 offset0:208 offset1:209
    ds_read2st64_b32 v[122:123], v235 offset0:210 offset1:211
    ds_read2st64_b32 v[124:125], v235 offset0:212 offset1:213
    ds_read2st64_b32 v[126:127], v235 offset0:214 offset1:215
    s_waitcnt lgkmcnt(15)
    v_perm_b32 v32, v65, v64, s42
    v_perm_b32 v33, v67, v66, s42
    v_perm_b32 v34, v69, v68, s42
    v_perm_b32 v35, v71, v70, s42
    v_perm_b32 v36, v73, v72, s42
    v_perm_b32 v37, v75, v74, s42
    v_perm_b32 v38, v77, v76, s42
    v_perm_b32 v39, v79, v78, s42
    v_perm_b32 v40, v81, v80, s42
    v_perm_b32 v41, v83, v82, s42
    v_perm_b32 v42, v85, v84, s42
    v_perm_b32 v43, v87, v86, s42
    v_perm_b32 v44, v89, v88, s42
    v_perm_b32 v45, v91, v90, s42
    v_perm_b32 v46, v93, v92, s42
    v_perm_b32 v47, v95, v94, s42
    s_waitcnt vmcnt(4)
    s_mov_b64 exec, 1
    v_mov_b32 v170, 0
    v_mov_b32 v171, 1
    ds_add_u32 v170, v171 offset:7236
    K1_AW3:
    ds_read_b32 v171, v170 offset:7236
    s_waitcnt lgkmcnt(0)
    v_cmp_gt_u32 vcc, 4, v171
    s_cbranch_vccnz K1_AW3
    s_mov_b64 exec, -1
    ds_read_b128 v[128:131], v224 offset:0
    ds_read_b128 v[132:135], v225 offset:0
    ds_read_b128 v[136:139], v226 offset:0
    ds_read_b128 v[140:143], v227 offset:0
    ds_read_b128 v[176:179], v228 offset:0
    ds_read_b128 v[180:183], v229 offset:0
    ds_read_b128 v[184:187], v230 offset:0
    ds_read_b128 v[188:191], v231 offset:0
    v_perm_b32 v48, v97, v96, s42
    v_perm_b32 v49, v99, v98, s42
    v_perm_b32 v50, v101, v100, s42
    v_perm_b32 v51, v103, v102, s42
    v_perm_b32 v52, v105, v104, s42
    v_perm_b32 v53, v107, v106, s42
    v_perm_b32 v54, v109, v108, s42
    v_perm_b32 v55, v111, v110, s42
    v_perm_b32 v56, v113, v112, s42
    v_perm_b32 v57, v115, v114, s42
    v_perm_b32 v58, v117, v116, s42
    v_perm_b32 v59, v119, v118, s42
    v_perm_b32 v60, v121, v120, s42
    v_perm_b32 v61, v123, v122, s42
    v_perm_b32 v62, v125, v124, s42
    v_perm_b32 v63, v127, v126, s42
    ds_read_b128 v[96:99], v224 offset:32768
    ds_read_b128 v[100:103], v225 offset:32768
    ds_read_b128 v[104:107], v226 offset:32768
    ds_read_b128 v[108:111], v227 offset:32768
    ds_read_b128 v[112:115], v228 offset:32768
    ds_read_b128 v[116:119], v229 offset:32768
    ds_read_b128 v[120:123], v230 offset:32768
    ds_read_b128 v[124:127], v231 offset:32768
    v_add_u32 v224, 0x10000, v224
    v_add_u32 v225, 0x10000, v225
    v_add_u32 v226, 0x10000, v226
    v_add_u32 v227, 0x10000, v227
    v_add_u32 v228, 0x10000, v228
    v_add_u32 v229, 0x10000, v229
    v_add_u32 v230, 0x10000, v230
    v_add_u32 v231, 0x10000, v231
    s_waitcnt lgkmcnt(8)
    v_mfma_f32_32x32x16_bf16 v[144:159], v[0:3], v[128:131], 0
    v_mfma_f32_32x32x16_bf16 v[144:159], v[4:7], v[132:135], v[144:159]
    v_mfma_f32_32x32x16_bf16 v[144:159], v[8:11], v[136:139], v[144:159]
    v_mfma_f32_32x32x16_bf16 v[144:159], v[12:15], v[140:143], v[144:159]
    v_mfma_f32_32x32x16_bf16 v[144:159], v[16:19], v[176:179], v[144:159]
    v_mfma_f32_32x32x16_bf16 v[144:159], v[20:23], v[180:183], v[144:159]
    v_mfma_f32_32x32x16_bf16 v[144:159], v[24:27], v[184:187], v[144:159]
    v_mfma_f32_32x32x16_bf16 v[144:159], v[28:31], v[188:191], v[144:159]
    v_mfma_f32_32x32x16_bf16 v[192:207], v[32:35], v[128:131], 0
    v_mfma_f32_32x32x16_bf16 v[192:207], v[36:39], v[132:135], v[192:207]
    v_mfma_f32_32x32x16_bf16 v[192:207], v[40:43], v[136:139], v[192:207]
    v_mfma_f32_32x32x16_bf16 v[192:207], v[44:47], v[140:143], v[192:207]
    v_mfma_f32_32x32x16_bf16 v[192:207], v[48:51], v[176:179], v[192:207]
    v_mfma_f32_32x32x16_bf16 v[192:207], v[52:55], v[180:183], v[192:207]
    v_mfma_f32_32x32x16_bf16 v[192:207], v[56:59], v[184:187], v[192:207]
    v_mfma_f32_32x32x16_bf16 v[192:207], v[60:63], v[188:191], v[192:207]
    s_waitcnt vmcnt(0)
    s_mov_b64 exec, 1
    v_mov_b32 v170, 0
    v_mov_b32 v171, 1
    ds_add_u32 v170, v171 offset:7240
    K1_AW4:
    ds_read_b32 v171, v170 offset:7240
    s_waitcnt lgkmcnt(0)
    v_cmp_gt_u32 vcc, 4, v171
    s_cbranch_vccnz K1_AW4
    s_mov_b64 exec, -1
    s_waitcnt lgkmcnt(0)
    ds_read_b128 v[128:131], v224 offset:0
    ds_read_b128 v[132:135], v225 offset:0
    ds_read_b128 v[136:139], v226 offset:0
    ds_read_b128 v[140:143], v227 offset:0
    ds_read_b128 v[176:179], v228 offset:0
    ds_read_b128 v[180:183], v229 offset:0
    ds_read_b128 v[184:187], v230 offset:0
    ds_read_b128 v[188:191], v231 offset:0
    v_mfma_f32_32x32x16_bf16 v[64:79], v[0:3], v[96:99], 0
    v_mul_f32 v144, v237, v144
    v_mul_f32 v145, v237, v145
    v_mul_f32 v146, v237, v146
    v_mul_f32 v147, v237, v147
    v_mfma_f32_32x32x16_bf16 v[64:79], v[4:7], v[100:103], v[64:79]
    v_mul_f32 v148, v237, v148
    v_mul_f32 v149, v237, v149
    v_mul_f32 v150, v237, v150
    v_mul_f32 v151, v237, v151
    v_mfma_f32_32x32x16_bf16 v[64:79], v[8:11], v[104:107], v[64:79]
    v_mul_f32 v152, v237, v152
    v_mul_f32 v153, v237, v153
    v_mul_f32 v154, v237, v154
    v_mul_f32 v155, v237, v155
    v_mfma_f32_32x32x16_bf16 v[64:79], v[12:15], v[108:111], v[64:79]
    v_mul_f32 v156, v237, v156
    v_mul_f32 v157, v237, v157
    v_mul_f32 v158, v237, v158
    v_mul_f32 v159, v237, v159
    v_mfma_f32_32x32x16_bf16 v[64:79], v[16:19], v[112:115], v[64:79]
    v_cvt_pk_bf16_f32 v144, v144, v145
    v_cvt_pk_bf16_f32 v145, v146, v147
    v_cvt_pk_bf16_f32 v146, v148, v149
    v_cvt_pk_bf16_f32 v147, v150, v151
    v_mfma_f32_32x32x16_bf16 v[64:79], v[20:23], v[116:119], v[64:79]
    v_cvt_pk_bf16_f32 v148, v152, v153
    v_cvt_pk_bf16_f32 v149, v154, v155
    v_cvt_pk_bf16_f32 v150, v156, v157
    v_cvt_pk_bf16_f32 v151, v158, v159
    v_mfma_f32_32x32x16_bf16 v[64:79], v[24:27], v[120:123], v[64:79]
    ds_write_b128 v212, v[144:147]
    ds_write_b128 v213, v[148:151]
    v_cvt_pk_bf16_f32 v192, v192, v193
    v_cvt_pk_bf16_f32 v193, v194, v195
    v_mfma_f32_32x32x16_bf16 v[64:79], v[28:31], v[124:127], v[64:79]
    v_cvt_pk_bf16_f32 v194, v196, v197
    v_cvt_pk_bf16_f32 v195, v198, v199
    v_cvt_pk_bf16_f32 v196, v200, v201
    v_cvt_pk_bf16_f32 v197, v202, v203
    v_mfma_f32_32x32x16_bf16 v[80:95], v[32:35], v[96:99], 0
    v_cvt_pk_bf16_f32 v198, v204, v205
    v_cvt_pk_bf16_f32 v199, v206, v207
    ds_write_b128 v214, v[192:195]
    ds_write_b128 v215, v[196:199]
    v_mfma_f32_32x32x16_bf16 v[80:95], v[36:39], v[100:103], v[80:95]
    ds_read_b128 v[152:155], v232 offset:0
    ds_read_b128 v[156:159], v232 offset:1024
    ds_read_b128 v[200:203], v232 offset:2048
    ds_read_b128 v[204:207], v232 offset:3072
    v_mfma_f32_32x32x16_bf16 v[80:95], v[40:43], v[104:107], v[80:95]
    v_mfma_f32_32x32x16_bf16 v[80:95], v[44:47], v[108:111], v[80:95]
    v_mfma_f32_32x32x16_bf16 v[80:95], v[48:51], v[112:115], v[80:95]
    s_movk_i32 s47, 0
    s_waitcnt lgkmcnt(3)
    buffer_store_dwordx4 v[152:155], v210, s[60:63], s47 offen offset:0 sc1
    v_mfma_f32_32x32x16_bf16 v[80:95], v[52:55], v[116:119], v[80:95]
    s_movk_i32 s47, 0
    s_waitcnt lgkmcnt(2)
    buffer_store_dwordx4 v[156:159], v210, s[60:63], s47 offen offset:1024 sc1
    v_mfma_f32_32x32x16_bf16 v[80:95], v[56:59], v[120:123], v[80:95]
    s_movk_i32 s47, 0
    s_waitcnt lgkmcnt(1)
    buffer_store_dwordx4 v[200:203], v210, s[60:63], s47 offen offset:2048 sc1
    v_mfma_f32_32x32x16_bf16 v[80:95], v[60:63], v[124:127], v[80:95]
    s_movk_i32 s47, 0
    s_waitcnt lgkmcnt(0)
    buffer_store_dwordx4 v[204:207], v210, s[60:63], s47 offen offset:3072 sc1
    s_waitcnt lgkmcnt(0)
    ds_read_b128 v[96:99], v224 offset:32768
    ds_read_b128 v[100:103], v225 offset:32768
    ds_read_b128 v[104:107], v226 offset:32768
    ds_read_b128 v[108:111], v227 offset:32768
    ds_read_b128 v[112:115], v228 offset:32768
    ds_read_b128 v[116:119], v229 offset:32768
    ds_read_b128 v[120:123], v230 offset:32768
    ds_read_b128 v[124:127], v231 offset:32768
    v_mfma_f32_32x32x16_bf16 v[144:159], v[0:3], v[128:131], 0
    v_mul_f32 v64, v237, v64
    v_mul_f32 v65, v237, v65
    v_mul_f32 v66, v237, v66
    v_mul_f32 v67, v237, v67
    v_mfma_f32_32x32x16_bf16 v[144:159], v[4:7], v[132:135], v[144:159]
    v_mul_f32 v68, v237, v68
    v_mul_f32 v69, v237, v69
    v_mul_f32 v70, v237, v70
    v_mul_f32 v71, v237, v71
    v_mfma_f32_32x32x16_bf16 v[144:159], v[8:11], v[136:139], v[144:159]
    v_mul_f32 v72, v237, v72
    v_mul_f32 v73, v237, v73
    v_mul_f32 v74, v237, v74
    v_mul_f32 v75, v237, v75
    v_mfma_f32_32x32x16_bf16 v[144:159], v[12:15], v[140:143], v[144:159]
    v_mul_f32 v76, v237, v76
    v_mul_f32 v77, v237, v77
    v_mul_f32 v78, v237, v78
    v_mul_f32 v79, v237, v79
    v_mfma_f32_32x32x16_bf16 v[144:159], v[16:19], v[176:179], v[144:159]
    v_cvt_pk_bf16_f32 v64, v64, v65
    v_cvt_pk_bf16_f32 v65, v66, v67
    v_cvt_pk_bf16_f32 v66, v68, v69
    v_cvt_pk_bf16_f32 v67, v70, v71
    v_mfma_f32_32x32x16_bf16 v[144:159], v[20:23], v[180:183], v[144:159]
    v_cvt_pk_bf16_f32 v68, v72, v73
    v_cvt_pk_bf16_f32 v69, v74, v75
    v_cvt_pk_bf16_f32 v70, v76, v77
    v_cvt_pk_bf16_f32 v71, v78, v79
    v_mfma_f32_32x32x16_bf16 v[144:159], v[24:27], v[184:187], v[144:159]
    ds_write_b128 v212, v[64:67]
    ds_write_b128 v213, v[68:71]
    v_cvt_pk_bf16_f32 v80, v80, v81
    v_cvt_pk_bf16_f32 v81, v82, v83
    v_mfma_f32_32x32x16_bf16 v[144:159], v[28:31], v[188:191], v[144:159]
    v_cvt_pk_bf16_f32 v82, v84, v85
    v_cvt_pk_bf16_f32 v83, v86, v87
    v_cvt_pk_bf16_f32 v84, v88, v89
    v_cvt_pk_bf16_f32 v85, v90, v91
    v_mfma_f32_32x32x16_bf16 v[192:207], v[32:35], v[128:131], 0
    v_cvt_pk_bf16_f32 v86, v92, v93
    v_cvt_pk_bf16_f32 v87, v94, v95
    ds_write_b128 v214, v[80:83]
    ds_write_b128 v215, v[84:87]
    v_mfma_f32_32x32x16_bf16 v[192:207], v[36:39], v[132:135], v[192:207]
    ds_read_b128 v[72:75], v232 offset:0
    ds_read_b128 v[76:79], v232 offset:1024
    ds_read_b128 v[88:91], v232 offset:2048
    ds_read_b128 v[92:95], v232 offset:3072
    v_mfma_f32_32x32x16_bf16 v[192:207], v[40:43], v[136:139], v[192:207]
    v_mfma_f32_32x32x16_bf16 v[192:207], v[44:47], v[140:143], v[192:207]
    v_mfma_f32_32x32x16_bf16 v[192:207], v[48:51], v[176:179], v[192:207]
    s_movk_i32 s47, 4096
    s_waitcnt lgkmcnt(3)
    buffer_store_dwordx4 v[72:75], v210, s[60:63], s47 offen offset:0 sc1
    v_mfma_f32_32x32x16_bf16 v[192:207], v[52:55], v[180:183], v[192:207]
    s_movk_i32 s47, 4096
    s_waitcnt lgkmcnt(2)
    buffer_store_dwordx4 v[76:79], v210, s[60:63], s47 offen offset:1024 sc1
    v_mfma_f32_32x32x16_bf16 v[192:207], v[56:59], v[184:187], v[192:207]
    s_movk_i32 s47, 4096
    s_waitcnt lgkmcnt(1)
    buffer_store_dwordx4 v[88:91], v210, s[60:63], s47 offen offset:2048 sc1
    v_mfma_f32_32x32x16_bf16 v[192:207], v[60:63], v[188:191], v[192:207]
    s_movk_i32 s47, 4096
    s_waitcnt lgkmcnt(0)
    buffer_store_dwordx4 v[92:95], v210, s[60:63], s47 offen offset:3072 sc1
    s_waitcnt lgkmcnt(0)
    s_nop 3
    v_lshlrev_b32 v172, 12, v209
    s_lshl_b32 s40, s25, 4
    s_add_u32 s40, s40, 0x2ba004
    s_mov_b64 exec, 63
    buffer_load_dword v173, v172, s[28:31], s40 offen sc1
    s_mov_b64 exec, -1
    v_mfma_f32_32x32x16_bf16 v[64:79], v[0:3], v[96:99], 0
    v_mul_f32 v144, v237, v144
    v_mul_f32 v145, v237, v145
    v_mul_f32 v146, v237, v146
    v_mul_f32 v147, v237, v147
    v_mfma_f32_32x32x16_bf16 v[64:79], v[4:7], v[100:103], v[64:79]
    v_mul_f32 v148, v237, v148
    v_mul_f32 v149, v237, v149
    v_mul_f32 v150, v237, v150
    v_mul_f32 v151, v237, v151
    v_mfma_f32_32x32x16_bf16 v[64:79], v[8:11], v[104:107], v[64:79]
    v_mul_f32 v152, v237, v152
    v_mul_f32 v153, v237, v153
    v_mul_f32 v154, v237, v154
    v_mul_f32 v155, v237, v155
    v_mfma_f32_32x32x16_bf16 v[64:79], v[12:15], v[108:111], v[64:79]
    v_mul_f32 v156, v237, v156
    v_mul_f32 v157, v237, v157
    v_mul_f32 v158, v237, v158
    v_mul_f32 v159, v237, v159
    v_mfma_f32_32x32x16_bf16 v[64:79], v[16:19], v[112:115], v[64:79]
    v_cvt_pk_bf16_f32 v144, v144, v145
    v_cvt_pk_bf16_f32 v145, v146, v147
    v_cvt_pk_bf16_f32 v146, v148, v149
    v_cvt_pk_bf16_f32 v147, v150, v151
    v_mfma_f32_32x32x16_bf16 v[64:79], v[20:23], v[116:119], v[64:79]
    v_cvt_pk_bf16_f32 v148, v152, v153
    v_cvt_pk_bf16_f32 v149, v154, v155
    v_cvt_pk_bf16_f32 v150, v156, v157
    v_cvt_pk_bf16_f32 v151, v158, v159
    v_mfma_f32_32x32x16_bf16 v[64:79], v[24:27], v[120:123], v[64:79]
    ds_write_b128 v212, v[144:147]
    ds_write_b128 v213, v[148:151]
    v_cvt_pk_bf16_f32 v192, v192, v193
    v_cvt_pk_bf16_f32 v193, v194, v195
    v_mfma_f32_32x32x16_bf16 v[64:79], v[28:31], v[124:127], v[64:79]
    v_cvt_pk_bf16_f32 v194, v196, v197
    v_cvt_pk_bf16_f32 v195, v198, v199
    v_cvt_pk_bf16_f32 v196, v200, v201
    v_cvt_pk_bf16_f32 v197, v202, v203
    v_mfma_f32_32x32x16_bf16 v[80:95], v[32:35], v[96:99], 0
    v_cvt_pk_bf16_f32 v198, v204, v205
    v_cvt_pk_bf16_f32 v199, v206, v207
    ds_write_b128 v214, v[192:195]
    ds_write_b128 v215, v[196:199]
    v_mfma_f32_32x32x16_bf16 v[80:95], v[36:39], v[100:103], v[80:95]
    ds_read_b128 v[152:155], v232 offset:0
    ds_read_b128 v[156:159], v232 offset:1024
    ds_read_b128 v[200:203], v232 offset:2048
    ds_read_b128 v[204:207], v232 offset:3072
    v_mfma_f32_32x32x16_bf16 v[80:95], v[40:43], v[104:107], v[80:95]
    v_mfma_f32_32x32x16_bf16 v[80:95], v[44:47], v[108:111], v[80:95]
    v_mfma_f32_32x32x16_bf16 v[80:95], v[48:51], v[112:115], v[80:95]
    s_movk_i32 s47, 8192
    s_waitcnt lgkmcnt(3)
    buffer_store_dwordx4 v[152:155], v210, s[60:63], s47 offen offset:0 sc1
    v_mfma_f32_32x32x16_bf16 v[80:95], v[52:55], v[116:119], v[80:95]
    s_movk_i32 s47, 8192
    s_waitcnt lgkmcnt(2)
    buffer_store_dwordx4 v[156:159], v210, s[60:63], s47 offen offset:1024 sc1
    v_mfma_f32_32x32x16_bf16 v[80:95], v[56:59], v[120:123], v[80:95]
    s_movk_i32 s47, 8192
    s_waitcnt lgkmcnt(1)
    buffer_store_dwordx4 v[200:203], v210, s[60:63], s47 offen offset:2048 sc1
    v_mfma_f32_32x32x16_bf16 v[80:95], v[60:63], v[124:127], v[80:95]
    s_movk_i32 s47, 8192
    s_waitcnt lgkmcnt(0)
    buffer_store_dwordx4 v[204:207], v210, s[60:63], s47 offen offset:3072 sc1
    v_mul_f32 v64, v237, v64
    v_mul_f32 v65, v237, v65
    v_mul_f32 v66, v237, v66
    v_mul_f32 v67, v237, v67
    v_mul_f32 v68, v237, v68
    v_mul_f32 v69, v237, v69
    v_mul_f32 v70, v237, v70
    v_mul_f32 v71, v237, v71
    v_mul_f32 v72, v237, v72
    v_mul_f32 v73, v237, v73
    v_mul_f32 v74, v237, v74
    v_mul_f32 v75, v237, v75
    v_mul_f32 v76, v237, v76
    v_mul_f32 v77, v237, v77
    v_mul_f32 v78, v237, v78
    v_mul_f32 v79, v237, v79
    v_cvt_pk_bf16_f32 v64, v64, v65
    v_cvt_pk_bf16_f32 v65, v66, v67
    v_cvt_pk_bf16_f32 v66, v68, v69
    v_cvt_pk_bf16_f32 v67, v70, v71
    v_cvt_pk_bf16_f32 v68, v72, v73
    v_cvt_pk_bf16_f32 v69, v74, v75
    v_cvt_pk_bf16_f32 v70, v76, v77
    v_cvt_pk_bf16_f32 v71, v78, v79
    ds_write_b128 v212, v[64:67]
    ds_write_b128 v213, v[68:71]
    v_cvt_pk_bf16_f32 v80, v80, v81
    v_cvt_pk_bf16_f32 v81, v82, v83
    v_cvt_pk_bf16_f32 v82, v84, v85
    v_cvt_pk_bf16_f32 v83, v86, v87
    v_cvt_pk_bf16_f32 v84, v88, v89
    v_cvt_pk_bf16_f32 v85, v90, v91
    v_cvt_pk_bf16_f32 v86, v92, v93
    v_cvt_pk_bf16_f32 v87, v94, v95
    ds_write_b128 v214, v[80:83]
    ds_write_b128 v215, v[84:87]
    ds_read_b128 v[72:75], v232 offset:0
    s_movk_i32 s47, 12288
    s_waitcnt lgkmcnt(0)
    buffer_store_dwordx4 v[72:75], v210, s[60:63], s47 offen offset:0 sc1
    v_and_b32 v30, 31, v209
    v_lshrrev_b32 v31, 5, v209
    s_lshr_b32 s66, s24, 1
    v_mov_b32 v34, v30
    v_bfe_u32 v35, v34, 1, 3
    v_xor_b32 v35, v35, v31
    v_lshlrev_b32 v35, 4, v35
    v_lshl_add_u32 v35, v34, 7, v35
    v_add_u32 v216, s44, v35
    v_xor_b32 v217, 32, v216
    v_xor_b32 v218, 64, v216
    v_xor_b32 v219, 96, v216
    v_and_b32 v42, 7, v209
    v_lshlrev_b32 v240, 4, v42
    v_lshlrev_b32 v241, 4, v31
    v_lshlrev_b32 v242, 5, v31
    v_lshrrev_b32 v43, 3, v209
    v_lshlrev_b32 v244, 2, v43
    v_add_u32 v244, 8192, v244
    v_lshlrev_b32 v245, 2, v34
    v_lshlrev_b32 v36, 2, v30
    v_lshl_add_u32 v246, v31, 1, v36
    s_lshl_b32 s41, s46, 7
    v_lshl_add_u32 v247, v31, 10, v36
    v_add_u32 v247, s41, v247
    s_lshl_b32 s47, s46, 15
    s_add_u32 s47, s47, 40960
    v_add_u32 v233, s47, v210
    v_add_u32 v234, 0x10000, v233
    s_mov_b32 s45, 0x00ffffff
    s_mov_b32 s72, 0
    s_mov_b32 s67, 0
    s_add_u32 s48, s22, 0x400
    s_addc_u32 s49, s23, 0
    s_mov_b32 s50, 0xc35c00
    s_mov_b32 s51, 0x00020000
    s_mov_b32 s52, s6
    s_mov_b32 s53, s7
    s_mov_b32 s54, 0xc35000
    s_mov_b32 s55, 0x00020000
    s_add_u32 s68, s20, s27
    s_addc_u32 s69, s21, 0
    s_mov_b32 s70, s100
    s_mov_b32 s71, 0x00020000
    s_mul_i32 s47, s46, 6400000
    s_add_u32 s8, s47, 3072
    s_add_u32 s9, s47, 2048
    s_add_u32 s10, s47, 1024
    s_add_u32 s11, s47, 0
    s_add_u32 s12, s47, 3203072
    s_add_u32 s13, s47, 3202048
    s_add_u32 s14, s47, 3201024
    s_add_u32 s15, s47, 3200000
    v_mov_b32 v170, 0
    s_mov_b64 exec, 1
    K1_AW5:
    ds_read_b32 v171, v170 offset:7248
    s_waitcnt lgkmcnt(0)
    v_cmp_gt_u32 vcc, 4, v171
    s_cbranch_vccnz K1_AW5
    s_mov_b64 exec, -1
    v_and_b32 v117, 3, v209
    v_bfe_u32 v118, v209, 3, 2
    v_lshl_or_b32 v117, v118, 2, v117
    v_bfe_u32 v118, v209, 2, 1
    v_lshl_or_b32 v117, v118, 4, v117
    v_lshlrev_b32 v117, v117, 1
    v_lshrrev_b32 v117, v241, v117
    v_bfe_u32 v118, v117, 8, 8
    v_and_b32 v117, 0xff, v117
    v_lshlrev_b32 v117, 4, v117
    v_lshlrev_b32 v118, 4, v118
    ds_read_b128 v[152:155], v117 offset:0
    ds_read_b128 v[156:159], v118 offset:0
    s_mov_b32 s47, 0x40000
    s_mov_b64 exec, 63
    s_waitcnt vmcnt(5)
    K1_WCHK:
    v_cmpx_ne_u32 vcc, s79, v173
    s_cbranch_execz K1_WOK
    s_sleep 2
    buffer_load_dword v173, v172, s[28:31], s40 offen sc1
    s_sub_u32 s47, s47, 1
    s_waitcnt vmcnt(0)
    s_cbranch_scc0 K1_WCHK
    K1_WOK:
    s_mov_b64 exec, -1
    v_mov_b32 v125, 1
    v_mov_b32 v124, 0
    v_mov_b32 v127, s79
    s_mov_b32 s40, 0x320000
    s_lshl_b32 s47, s25, 7
    v_mov_b32 v126, s47
    s_mov_b64 exec, 1
    s_waitcnt vmcnt(0)
    ds_add_rtn_u32 v125, v124, v125 offset:7184
    s_waitcnt lgkmcnt(0)
    v_cmpx_eq_u32 vcc, 3, v125
    buffer_store_dword v127, v126, s[28:31], s40 offen sc1
    s_mov_b64 exec, -1
    s_and_b32 s43, s24, 3
    s_lshl_b32 s42, s43, 14
    s_add_u32 s42, s42, 0x300000
    s_lshl_b32 s43, s43, 15
    s_add_u32 s43, s43, 32768
    s_add_u32 m0, s43, 8192
    s_add_u32 s41, s42, 0
    buffer_load_dwordx4 v210, s[28:31], s41 offen offset:0 sc1 lds
    buffer_load_dwordx4 v210, s[28:31], s41 offen offset:1024 sc1 lds
    buffer_load_dwordx4 v210, s[28:31], s41 offen offset:2048 sc1 lds
    buffer_load_dwordx4 v210, s[28:31], s41 offen offset:3072 sc1 lds
    s_add_u32 m0, s43, 12288
    s_add_u32 s41, s42, 4096
    buffer_load_dwordx4 v210, s[28:31], s41 offen offset:0 sc1 lds
    buffer_load_dwordx4 v210, s[28:31], s41 offen offset:1024 sc1 lds
    buffer_load_dwordx4 v210, s[28:31], s41 offen offset:2048 sc1 lds
    buffer_load_dwordx4 v210, s[28:31], s41 offen offset:3072 sc1 lds
    s_add_u32 m0, s43, 24576
    s_add_u32 s41, s42, 8192
    buffer_load_dwordx4 v210, s[28:31], s41 offen offset:0 sc1 lds
    buffer_load_dwordx4 v210, s[28:31], s41 offen offset:1024 sc1 lds
    buffer_load_dwordx4 v210, s[28:31], s41 offen offset:2048 sc1 lds
    buffer_load_dwordx4 v210, s[28:31], s41 offen offset:3072 sc1 lds
    s_add_u32 m0, s43, 28672
    s_add_u32 s41, s42, 12288
    buffer_load_dwordx4 v210, s[28:31], s41 offen offset:0 sc1 lds
    buffer_load_dwordx4 v210, s[28:31], s41 offen offset:1024 sc1 lds
    buffer_load_dwordx4 v210, s[28:31], s41 offen offset:2048 sc1 lds
    buffer_load_dwordx4 v210, s[28:31], s41 offen offset:3072 sc1 lds
    s_lshl_b32 s41, s46, 11
    s_add_u32 s41, s41, 0x318000
    buffer_load_dwordx4 v[144:147], v210, s[28:31], s41 offen sc1
    buffer_load_dwordx4 v[148:151], v210, s[28:31], s41 offen offset:1024 sc1
K1_JOIN:
    v_lshlrev_b32 v119, 3, v209
    v_mov_b32 v124, 0
    s_mov_b32 s40, 0x320000
    v_mov_b32 v127, s79
    s_waitcnt lgkmcnt(0)
    s_barrier
    s_cmp_ge_u32 s24, 4
    s_cbranch_scc1 K2_TPOST
    ds_read_b64 v[120:121], v119 offset:6144
    ds_read_b32 v124, v124 offset:7168
    s_waitcnt lgkmcnt(0)
    v_add_u32 v122, v120, v121
    v_mov_b32 v123, v122
    s_nop 1
    v_add_u32_dpp v123, v123, v123 row_shr:1 row_mask:0xf bank_mask:0xf bound_ctrl:0
    s_nop 1
    v_add_u32_dpp v123, v123, v123 row_shr:2 row_mask:0xf bank_mask:0xf bound_ctrl:0
    s_nop 1
    v_add_u32_dpp v123, v123, v123 row_shr:4 row_mask:0xf bank_mask:0xf bound_ctrl:0
    s_nop 1
    v_add_u32_dpp v123, v123, v123 row_shr:8 row_mask:0xf bank_mask:0xf bound_ctrl:0
    v_readfirstlane_b32 s73, v124
    v_readlane_b32 s74, v123, 15
    v_readlane_b32 s75, v123, 31
    v_readlane_b32 s76, v123, 47
    v_readlane_b32 s77, v123, 63
    v_sub_u32 v124, v123, v122
    s_sub_i32 s36, s74, s75
    s_sub_i32 s37, s76, s77
    s_add_i32 s38, s36, s37
    s_sub_i32 s39, s36, s37
    s_add_u32 s36, s74, s75
    s_sub_i32 s36, s36, s76
    s_sub_i32 s36, s36, s77
    s_abs_i32 s38, s38
    s_abs_i32 s39, s39
    s_abs_i32 s36, s36
    s_movk_i32 s37, 0x3210
    s_min_u32 s38, s39, s38
    s_cselect_b32 s37, 0x2310, s37
    s_cmp_lt_u32 s36, s38
    s_cselect_b32 s37, 0x3120, s37
    s_lshl_b32 s66, s66, 2
    s_lshr_b32 s66, s37, s66
    s_and_b32 s66, s66, 3
    s_cmp_eq_u32 s66, 1
    s_cselect_b32 s36, s75, s74
    s_cmp_eq_u32 s66, 2
    s_cselect_b32 s36, s76, s36
    s_cmp_eq_u32 s66, 3
    s_cselect_b32 s36, s77, s36
    s_sub_u32 s36, s36, 1
    s_and_b32 s36, s36, 16
    s_add_u32 s74, s74, 31
    s_and_b32 s74, s74, 0xffffffe0
    s_add_u32 s75, s75, 31
    s_and_b32 s75, s75, 0xffffffe0
    s_add_u32 s76, s76, 31
    s_and_b32 s76, s76, 0xffffffe0
    s_add_u32 s77, s77, 31
    s_and_b32 s77, s77, 0xffffffe0
    s_mov_b32 s78, 0
    s_add_u32 s80, s74, s75
    s_add_u32 s81, s80, s76
    s_add_u32 s82, s81, s77
    s_mov_b32 exec_lo, 0xffff0000
    s_mov_b32 exec_hi, 0
    v_add_u32 v124, s74, v124
    s_mov_b32 exec_lo, 0
    s_mov_b32 exec_hi, 0xffff
    v_add_u32 v124, s80, v124
    s_mov_b32 exec_hi, 0xffff0000
    v_add_u32 v124, s81, v124
    s_mov_b64 exec, -1
    v_add_u32 v125, v124, v120
    ds_write_b64 v119, v[124:125] offset:6656
    ds_read_b32 v64, v64 offset:6656
    ds_read_b32 v65, v65 offset:6656
    ds_read_b32 v66, v66 offset:6656
    ds_read_b32 v67, v67 offset:6656
    ds_read_b32 v68, v68 offset:6656
    ds_read_b32 v69, v69 offset:6656
    ds_read_b32 v70, v70 offset:6656
    ds_read_b32 v71, v71 offset:6656
    ds_read_b32 v72, v72 offset:6656
    ds_read_b32 v73, v73 offset:6656
    s_cmp_gt_u32 s82, 2048
    s_cselect_b32 s73, 1, s73
    s_min_u32 s82, s74, s75
    s_min_u32 s83, s76, s77
    s_min_u32 s82, s82, s83
    s_lshr_b32 s82, s82, 5
    s_cmp_lt_u32 s24, 4
    s_cselect_b32 s83, 0, s82
    s_cselect_b32 s82, s82, 0
    s_cmp_eq_u32 s66, 1
    s_cselect_b32 s78, s74, s78
    s_cselect_b32 s74, s75, s74
    s_cmp_eq_u32 s66, 2
    s_cselect_b32 s74, s76, s74
    s_cselect_b32 s78, s80, s78
    s_cmp_eq_u32 s66, 3
    s_cselect_b32 s74, s77, s74
    s_cselect_b32 s78, s81, s78
    s_lshr_b32 s74, s74, 5
    s_lshl_b32 s47, s78, 2
    v_add_u32 v236, s47, v244
    v_add_u32 v237, s47, v245
    v_add_u32 v238, s47, v246
    s_mov_b32 s75, 0
    s_cmp_lg_u32 s73, 0
    s_cselect_b32 s72, 1, 0
    s_cselect_b32 s74, 0, s74
    s_lshl_b32 s47, s25, 2
    s_add_u32 s47, s47, s66
    s_mul_i32 s47, s47, 3125
    s_add_u32 s101, s47, 3252
    s_add_u32 s47, s47, 127
    s_lshr_b32 s47, s47, 7
    s_lshr_b32 s101, s101, 7
    s_sub_u32 s101, s47, s101
    s_add_u32 s101, s101, 24
    s_sub_u32 s47, s47, s3
    v_and_b32 v117, 31, v209
    v_add_u32 v117, s47, v117
    v_and_b32 v118, 15, v117
    v_lshrrev_b32 v117, 4, v117
    v_lshlrev_b32 v117, 14, v117
    v_lshl_add_u32 v117, v118, 8, v117
    v_lshl_add_u32 v117, v118, 4, v117
    v_xor_b32 v211, v117, v241
    s_lshl_b32 s47, s47, 8
    v_add_u32 v247, s47, v247
    v_add_u32 v235, 0x1000, v247
    ds_read_b128 v[128:131], v211 offset:32768
    s_lshl_b32 s41, s46, 11
    s_add_u32 s41, s41, 0x318000
    buffer_load_dwordx4 v[144:147], v210, s[28:31], s41 offen sc1
    buffer_load_dwordx4 v[148:151], v210, s[28:31], s41 offen offset:1024 sc1
    buffer_load_dword v220, v247, s[32:35], 0 offen offset:0
    buffer_load_dword v221, v247, s[32:35], 0 offen offset:256
    buffer_load_dword v222, v247, s[32:35], 0 offen offset:512
    buffer_load_dword v223, v247, s[32:35], 0 offen offset:768
    buffer_load_dword v239, v247, s[32:35], 0 offen offset:2048
    buffer_load_dword v252, v247, s[32:35], 0 offen offset:2304
    buffer_load_dword v253, v247, s[32:35], 0 offen offset:2560
    buffer_load_dword v254, v247, s[32:35], 0 offen offset:2816
    buffer_load_dword v255, v235, s[32:35], 0 offen offset:0
    buffer_load_dword v173, v235, s[32:35], 0 offen offset:256
    buffer_load_dword v174, v235, s[32:35], 0 offen offset:512
    buffer_load_dword v175, v235, s[32:35], 0 offen offset:768
    buffer_load_dword v243, v235, s[32:35], 0 offen offset:2048
    s_cmp_lg_u32 s72, 0
    s_cbranch_scc1 K2_SD
    s_waitcnt lgkmcnt(0)
    v_cmpx_lt_i32 vcc, 0, v249
    v_add_u32 v64, v64, v74
    v_lshlrev_b32 v120, 2, v64
    v_bfe_u32 v122, v64, 1, 3
    v_lshl_or_b32 v121, v106, 3, v122
    v_lshlrev_b32 v121, 4, v121
    ds_write2st64_b32 v120, v121, v84 offset0:32 offset1:64
    v_bfi_b32 v123, 31, v96, v64
    v_lshlrev_b32 v123, 2, v123
    v_and_b32 v124, 4, v64
    v_lshrrev_b32 v125, 1, v64
    v_bfi_b32 v125, 3, v64, v125
    v_lshlrev_b32 v124, 2, v124
    v_bfi_b32 v124, 15, v125, v124
    v_lshlrev_b32 v124, v124, v116
    ds_or_b32 v123, v124 offset:24576
    v_cmpx_lt_i32 vcc, 64, v249
    s_cbranch_execz K2_SD
    v_add_u32 v65, v65, v75
    v_lshlrev_b32 v120, 2, v65
    v_bfe_u32 v122, v65, 1, 3
    v_lshl_or_b32 v121, v107, 3, v122
    v_lshlrev_b32 v121, 4, v121
    ds_write2st64_b32 v120, v121, v85 offset0:32 offset1:64
    v_bfi_b32 v123, 31, v97, v65
    v_lshlrev_b32 v123, 2, v123
    v_and_b32 v124, 4, v65
    v_lshrrev_b32 v125, 1, v65
    v_bfi_b32 v125, 3, v65, v125
    v_lshlrev_b32 v124, 2, v124
    v_bfi_b32 v124, 15, v125, v124
    v_lshlrev_b32 v124, v124, v116
    ds_or_b32 v123, v124 offset:24576
    v_cmpx_lt_i32 vcc, 0x80, v249
    v_add_u32 v66, v66, v76
    v_lshlrev_b32 v120, 2, v66
    v_bfe_u32 v122, v66, 1, 3
    v_lshl_or_b32 v121, v108, 3, v122
    v_lshlrev_b32 v121, 4, v121
    ds_write2st64_b32 v120, v121, v86 offset0:32 offset1:64
    v_bfi_b32 v123, 31, v98, v66
    v_lshlrev_b32 v123, 2, v123
    v_and_b32 v124, 4, v66
    v_lshrrev_b32 v125, 1, v66
    v_bfi_b32 v125, 3, v66, v125
    v_lshlrev_b32 v124, 2, v124
    v_bfi_b32 v124, 15, v125, v124
    v_lshlrev_b32 v124, v124, v116
    ds_or_b32 v123, v124 offset:24576
    v_cmpx_lt_i32 vcc, 0xc0, v249
    v_add_u32 v67, v67, v77
    v_lshlrev_b32 v120, 2, v67
    v_bfe_u32 v122, v67, 1, 3
    v_lshl_or_b32 v121, v109, 3, v122
    v_lshlrev_b32 v121, 4, v121
    ds_write2st64_b32 v120, v121, v87 offset0:32 offset1:64
    v_bfi_b32 v123, 31, v99, v67
    v_lshlrev_b32 v123, 2, v123
    v_and_b32 v124, 4, v67
    v_lshrrev_b32 v125, 1, v67
    v_bfi_b32 v125, 3, v67, v125
    v_lshlrev_b32 v124, 2, v124
    v_bfi_b32 v124, 15, v125, v124
    v_lshlrev_b32 v124, v124, v116
    ds_or_b32 v123, v124 offset:24576
    v_cmpx_lt_i32 vcc, 0x100, v249
    v_add_u32 v68, v68, v78
    v_lshlrev_b32 v120, 2, v68
    v_bfe_u32 v122, v68, 1, 3
    v_lshl_or_b32 v121, v110, 3, v122
    v_lshlrev_b32 v121, 4, v121
    ds_write2st64_b32 v120, v121, v88 offset0:32 offset1:64
    v_bfi_b32 v123, 31, v100, v68
    v_lshlrev_b32 v123, 2, v123
    v_and_b32 v124, 4, v68
    v_lshrrev_b32 v125, 1, v68
    v_bfi_b32 v125, 3, v68, v125
    v_lshlrev_b32 v124, 2, v124
    v_bfi_b32 v124, 15, v125, v124
    v_lshlrev_b32 v124, v124, v116
    ds_or_b32 v123, v124 offset:24576
    v_cmpx_lt_i32 vcc, 0x140, v249
    v_add_u32 v69, v69, v79
    v_lshlrev_b32 v120, 2, v69
    v_bfe_u32 v122, v69, 1, 3
    v_lshl_or_b32 v121, v111, 3, v122
    v_lshlrev_b32 v121, 4, v121
    ds_write2st64_b32 v120, v121, v89 offset0:32 offset1:64
    v_bfi_b32 v123, 31, v101, v69
    v_lshlrev_b32 v123, 2, v123
    v_and_b32 v124, 4, v69
    v_lshrrev_b32 v125, 1, v69
    v_bfi_b32 v125, 3, v69, v125
    v_lshlrev_b32 v124, 2, v124
    v_bfi_b32 v124, 15, v125, v124
    v_lshlrev_b32 v124, v124, v116
    ds_or_b32 v123, v124 offset:24576
    v_cmpx_lt_i32 vcc, 0x180, v249
    s_cbranch_execz K2_SD
    v_add_u32 v70, v70, v80
    v_lshlrev_b32 v120, 2, v70
    v_bfe_u32 v122, v70, 1, 3
    v_lshl_or_b32 v121, v112, 3, v122
    v_lshlrev_b32 v121, 4, v121
    ds_write2st64_b32 v120, v121, v90 offset0:32 offset1:64
    v_bfi_b32 v123, 31, v102, v70
    v_lshlrev_b32 v123, 2, v123
    v_and_b32 v124, 4, v70
    v_lshrrev_b32 v125, 1, v70
    v_bfi_b32 v125, 3, v70, v125
    v_lshlrev_b32 v124, 2, v124
    v_bfi_b32 v124, 15, v125, v124
    v_lshlrev_b32 v124, v124, v116
    ds_or_b32 v123, v124 offset:24576
    v_cmpx_lt_i32 vcc, 0x1c0, v249
    s_cbranch_execz K2_SD
    v_add_u32 v71, v71, v81
    v_lshlrev_b32 v120, 2, v71
    v_bfe_u32 v122, v71, 1, 3
    v_lshl_or_b32 v121, v113, 3, v122
    v_lshlrev_b32 v121, 4, v121
    ds_write2st64_b32 v120, v121, v91 offset0:32 offset1:64
    v_bfi_b32 v123, 31, v103, v71
    v_lshlrev_b32 v123, 2, v123
    v_and_b32 v124, 4, v71
    v_lshrrev_b32 v125, 1, v71
    v_bfi_b32 v125, 3, v71, v125
    v_lshlrev_b32 v124, 2, v124
    v_bfi_b32 v124, 15, v125, v124
    v_lshlrev_b32 v124, v124, v116
    ds_or_b32 v123, v124 offset:24576
    v_cmpx_lt_i32 vcc, 0x200, v249
    s_cbranch_execz K2_SD
    v_add_u32 v72, v72, v82
    v_lshlrev_b32 v120, 2, v72
    v_bfe_u32 v122, v72, 1, 3
    v_lshl_or_b32 v121, v114, 3, v122
    v_lshlrev_b32 v121, 4, v121
    ds_write2st64_b32 v120, v121, v92 offset0:32 offset1:64
    v_bfi_b32 v123, 31, v104, v72
    v_lshlrev_b32 v123, 2, v123
    v_and_b32 v124, 4, v72
    v_lshrrev_b32 v125, 1, v72
    v_bfi_b32 v125, 3, v72, v125
    v_lshlrev_b32 v124, 2, v124
    v_bfi_b32 v124, 15, v125, v124
    v_lshlrev_b32 v124, v124, v116
    ds_or_b32 v123, v124 offset:24576
    v_cmpx_lt_i32 vcc, 0x240, v249
    s_cbranch_execz K2_SD
    v_add_u32 v73, v73, v83
    v_lshlrev_b32 v120, 2, v73
    v_bfe_u32 v122, v73, 1, 3
    v_lshl_or_b32 v121, v115, 3, v122
    v_lshlrev_b32 v121, 4, v121
    ds_write2st64_b32 v120, v121, v93 offset0:32 offset1:64
    v_bfi_b32 v123, 31, v105, v73
    v_lshlrev_b32 v123, 2, v123
    v_and_b32 v124, 4, v73
    v_lshrrev_b32 v125, 1, v73
    v_bfi_b32 v125, 3, v73, v125
    v_lshlrev_b32 v124, 2, v124
    v_bfi_b32 v124, 15, v125, v124
    v_lshlrev_b32 v124, v124, v116
    ds_or_b32 v123, v124 offset:24576
    K2_SD:
    s_mov_b64 exec, -1
    v_xor_b32 v117, 32, v211
    ds_read_b128 v[132:135], v117 offset:32768
    v_xor_b32 v117, 64, v211
    ds_read_b128 v[136:139], v117 offset:32768
    v_xor_b32 v117, 96, v211
    ds_read_b128 v[140:143], v117 offset:32768
    v_xor_b32 v117, 128, v211
    ds_read_b128 v[176:179], v117 offset:32768
    v_xor_b32 v117, 160, v211
    ds_read_b128 v[180:183], v117 offset:32768
    v_xor_b32 v117, 192, v211
    ds_read_b128 v[184:187], v117 offset:32768
    v_xor_b32 v117, 224, v211
    ds_read_b128 v[188:191], v117 offset:32768
    s_branch K2_SYNC2
    K2_TPOST:
    ds_read_b64 v[120:121], v119 offset:6144
    ds_read_b32 v124, v124 offset:7168
    s_waitcnt lgkmcnt(0)
    v_add_u32 v122, v120, v121
    v_mov_b32 v123, v122
    s_nop 1
    v_add_u32_dpp v123, v123, v123 row_shr:1 row_mask:0xf bank_mask:0xf bound_ctrl:0
    s_nop 1
    v_add_u32_dpp v123, v123, v123 row_shr:2 row_mask:0xf bank_mask:0xf bound_ctrl:0
    s_nop 1
    v_add_u32_dpp v123, v123, v123 row_shr:4 row_mask:0xf bank_mask:0xf bound_ctrl:0
    s_nop 1
    v_add_u32_dpp v123, v123, v123 row_shr:8 row_mask:0xf bank_mask:0xf bound_ctrl:0
    v_readfirstlane_b32 s73, v124
    v_readlane_b32 s74, v123, 15
    v_readlane_b32 s75, v123, 31
    v_readlane_b32 s76, v123, 47
    v_readlane_b32 s77, v123, 63
    v_sub_u32 v124, v123, v122
    s_sub_i32 s36, s74, s75
    s_sub_i32 s37, s76, s77
    s_add_i32 s38, s36, s37
    s_sub_i32 s39, s36, s37
    s_add_u32 s36, s74, s75
    s_sub_i32 s36, s36, s76
    s_sub_i32 s36, s36, s77
    s_abs_i32 s38, s38
    s_abs_i32 s39, s39
    s_abs_i32 s36, s36
    s_movk_i32 s37, 0x3210
    s_min_u32 s38, s39, s38
    s_cselect_b32 s37, 0x2310, s37
    s_cmp_lt_u32 s36, s38
    s_cselect_b32 s37, 0x3120, s37
    s_lshl_b32 s66, s66, 2
    s_lshr_b32 s66, s37, s66
    s_and_b32 s66, s66, 3
    s_cmp_eq_u32 s66, 1
    s_cselect_b32 s36, s75, s74
    s_cmp_eq_u32 s66, 2
    s_cselect_b32 s36, s76, s36
    s_cmp_eq_u32 s66, 3
    s_cselect_b32 s36, s77, s36
    s_sub_u32 s36, s36, 1
    s_and_b32 s36, s36, 16
    s_add_u32 s74, s74, 31
    s_and_b32 s74, s74, 0xffffffe0
    s_add_u32 s75, s75, 31
    s_and_b32 s75, s75, 0xffffffe0
    s_add_u32 s76, s76, 31
    s_and_b32 s76, s76, 0xffffffe0
    s_add_u32 s77, s77, 31
    s_and_b32 s77, s77, 0xffffffe0
    s_mov_b32 s78, 0
    s_add_u32 s80, s74, s75
    s_add_u32 s81, s80, s76
    s_add_u32 s82, s81, s77
    s_cmp_gt_u32 s82, 2048
    s_cselect_b32 s73, 1, s73
    s_min_u32 s82, s74, s75
    s_min_u32 s83, s76, s77
    s_min_u32 s82, s82, s83
    s_lshr_b32 s82, s82, 5
    s_cmp_lt_u32 s24, 4
    s_cselect_b32 s83, 0, s82
    s_cselect_b32 s82, s82, 0
    s_cmp_eq_u32 s66, 1
    s_cselect_b32 s78, s74, s78
    s_cselect_b32 s74, s75, s74
    s_cmp_eq_u32 s66, 2
    s_cselect_b32 s74, s76, s74
    s_cselect_b32 s78, s80, s78
    s_cmp_eq_u32 s66, 3
    s_cselect_b32 s74, s77, s74
    s_cselect_b32 s78, s81, s78
    s_lshr_b32 s74, s74, 5
    s_lshl_b32 s47, s78, 2
    v_add_u32 v236, s47, v244
    v_add_u32 v237, s47, v245
    v_add_u32 v238, s47, v246
    s_mov_b32 s75, 0
    s_cmp_lg_u32 s73, 0
    s_cselect_b32 s72, 1, 0
    s_cselect_b32 s74, 0, s74
    s_lshl_b32 s47, s25, 2
    s_add_u32 s47, s47, s66
    s_mul_i32 s47, s47, 3125
    s_add_u32 s101, s47, 3252
    s_add_u32 s47, s47, 127
    s_lshr_b32 s47, s47, 7
    s_lshr_b32 s101, s101, 7
    s_sub_u32 s101, s47, s101
    s_add_u32 s101, s101, 24
    s_sub_u32 s47, s47, s3
    v_and_b32 v117, 31, v209
    v_add_u32 v117, s47, v117
    v_and_b32 v118, 15, v117
    v_lshrrev_b32 v117, 4, v117
    v_lshlrev_b32 v117, 14, v117
    v_lshl_add_u32 v117, v118, 8, v117
    v_lshl_add_u32 v117, v118, 4, v117
    v_xor_b32 v211, v117, v241
    s_lshl_b32 s47, s47, 8
    v_add_u32 v247, s47, v247
    v_add_u32 v235, 0x1000, v247
    ds_read_b128 v[128:131], v211 offset:32768
    v_xor_b32 v117, 32, v211
    ds_read_b128 v[132:135], v117 offset:32768
    v_xor_b32 v117, 64, v211
    ds_read_b128 v[136:139], v117 offset:32768
    v_xor_b32 v117, 96, v211
    ds_read_b128 v[140:143], v117 offset:32768
    v_xor_b32 v117, 128, v211
    ds_read_b128 v[176:179], v117 offset:32768
    v_xor_b32 v117, 160, v211
    ds_read_b128 v[180:183], v117 offset:32768
    v_xor_b32 v117, 192, v211
    ds_read_b128 v[184:187], v117 offset:32768
    v_xor_b32 v117, 224, v211
    ds_read_b128 v[188:191], v117 offset:32768
    v_and_b32 v126, 0xff, v248
    v_lshlrev_b32 v126, 7, v126
    s_mov_b32 s47, 0x40000
    buffer_load_dword v125, v126, s[28:31], s40 offen sc1
    buffer_load_dword v220, v247, s[32:35], 0 offen offset:0
    buffer_load_dword v221, v247, s[32:35], 0 offen offset:256
    buffer_load_dword v222, v247, s[32:35], 0 offen offset:512
    buffer_load_dword v223, v247, s[32:35], 0 offen offset:768
    buffer_load_dword v239, v247, s[32:35], 0 offen offset:2048
    buffer_load_dword v252, v247, s[32:35], 0 offen offset:2304
    buffer_load_dword v253, v247, s[32:35], 0 offen offset:2560
    buffer_load_dword v254, v247, s[32:35], 0 offen offset:2816
    buffer_load_dword v255, v235, s[32:35], 0 offen offset:0
    buffer_load_dword v173, v235, s[32:35], 0 offen offset:256
    buffer_load_dword v174, v235, s[32:35], 0 offen offset:512
    buffer_load_dword v175, v235, s[32:35], 0 offen offset:768
    buffer_load_dword v243, v235, s[32:35], 0 offen offset:2048
    s_waitcnt vmcnt(13)
    s_branch K2_FCMP
    K2_FCHK:
    buffer_load_dword v125, v126, s[28:31], s40 offen sc1
    s_waitcnt vmcnt(0)
    K2_FCMP:
    v_cmpx_ne_u32 vcc, s79, v125
    s_cbranch_execz K2_FOK
    s_sleep 2
    s_sub_u32 s47, s47, 1
    s_cbranch_scc0 K2_FCHK
    K2_FOK:
    s_mov_b64 exec, -1
    K2_SYNC2:
    s_setprio 0
    s_waitcnt lgkmcnt(0)
    s_barrier
    s_or_b32 s47, s2, s24
    s_cbranch_scc1 K2_NOGEN
    s_mov_b32 s40, 0x330000
    s_mov_b64 exec, 1
    buffer_store_dword v127, v119, s[28:31], s40 offen sc1
    s_mov_b64 exec, -1
K2_NOGEN:
    ds_read2_b32 v[224:225], v236 offset0:0 offset1:8
    ds_read2_b32 v[226:227], v236 offset0:16 offset1:24
    ds_read_b32 v232, v237 offset:16384
    ds_read2_b32 v[228:229], v236 offset0:32 offset1:40
    ds_read2_b32 v[230:231], v236 offset0:48 offset1:56
    s_add_u32 s47, s75, 0
    s_cmp_lt_u32 s47, s74
    s_cselect_b32 s50, 0xc35c00, 0
    s_cselect_b32 s54, 0xc35000, 0
    s_add_u32 m0, s44, 0
    s_waitcnt lgkmcnt(0)
    v_xor_b32 v224, v224, v240
    v_xor_b32 v225, v225, v240
    v_xor_b32 v226, v226, v240
    v_xor_b32 v227, v227, v240
    buffer_load_dwordx4 v224, s[48:51], s8 offen offset:0 sc1 lds
    ds_read_b128 v[0:3], v234 offset:0
    ds_read_b128 v[4:7], v234 offset:1024
    ds_read_b128 v[8:11], v234 offset:2048
    ds_read_b128 v[12:15], v234 offset:3072
    buffer_load_dwordx4 v225, s[48:51], s9 offen offset:1024 sc1 lds
    ds_read_b128 v[16:19], v234 offset:4096
    ds_read_b128 v[20:23], v234 offset:5120
    ds_read_b128 v[24:27], v234 offset:6144
    ds_read_b128 v[28:31], v234 offset:7168
    buffer_load_dwordx4 v226, s[48:51], s10 offen offset:2048 sc1 lds
    ds_read_b128 v[32:35], v234 offset:16384
    ds_read_b128 v[36:39], v234 offset:17408
    ds_read_b128 v[40:43], v234 offset:18432
    ds_read_b128 v[44:47], v234 offset:19456
    buffer_load_dwordx4 v227, s[48:51], s11 offen offset:3072 sc1 lds
    ds_read_b128 v[48:51], v234 offset:20480
    ds_read_b128 v[52:55], v234 offset:21504
    ds_read_b128 v[56:59], v234 offset:22528
    ds_read_b128 v[60:63], v234 offset:23552
    v_and_or_b32 v232, v232, s45, v241
    buffer_load_dwordx4 v[192:195], v232, s[52:55], 0 offen
    ds_read_b32 v232, v237 offset:16512
    s_add_u32 m0, s44, 4096
    v_xor_b32 v228, v228, v240
    v_xor_b32 v229, v229, v240
    v_xor_b32 v230, v230, v240
    v_xor_b32 v231, v231, v240
    ds_read_b128 v[64:67], v233 offset:0
    ds_read_b128 v[68:71], v233 offset:1024
    ds_read_b128 v[72:75], v233 offset:2048
    ds_read_b128 v[76:79], v233 offset:3072
    buffer_load_dwordx4 v224, s[48:51], s12 offen offset:0 sc1 lds
    ds_read_b128 v[80:83], v233 offset:4096
    ds_read_b128 v[84:87], v233 offset:5120
    ds_read_b128 v[88:91], v233 offset:6144
    ds_read_b128 v[92:95], v233 offset:7168
    buffer_load_dwordx4 v225, s[48:51], s13 offen offset:1024 sc1 lds
    ds_read_b128 v[96:99], v233 offset:16384
    ds_read_b128 v[100:103], v233 offset:17408
    ds_read_b128 v[104:107], v233 offset:18432
    ds_read_b128 v[108:111], v233 offset:19456
    buffer_load_dwordx4 v226, s[48:51], s14 offen offset:2048 sc1 lds
    ds_read_b128 v[112:115], v233 offset:20480
    ds_read_b128 v[116:119], v233 offset:21504
    ds_read_b128 v[120:123], v233 offset:22528
    ds_read_b128 v[124:127], v233 offset:23552
    buffer_load_dwordx4 v227, s[48:51], s15 offen offset:3072 sc1 lds
    s_waitcnt lgkmcnt(0)
    s_barrier
    s_add_u32 s47, s75, 1
    s_cmp_lt_u32 s47, s74
    s_cselect_b32 s50, 0xc35c00, 0
    s_cselect_b32 s54, 0xc35000, 0
    s_add_u32 m0, s44, 8192
    s_waitcnt lgkmcnt(0)
    buffer_load_dwordx4 v228, s[48:51], s8 offen offset:0 sc1 lds
    v_mfma_f32_32x32x16_bf16 v[200:215], v[128:131], v[0:3], 0
    v_mfma_f32_32x32x16_bf16 v[200:215], v[132:135], v[4:7], v[200:215]
    v_mfma_f32_32x32x16_bf16 v[200:215], v[136:139], v[8:11], v[200:215]
    buffer_load_dwordx4 v229, s[48:51], s9 offen offset:1024 sc1 lds
    v_mfma_f32_32x32x16_bf16 v[200:215], v[140:143], v[12:15], v[200:215]
    v_mfma_f32_32x32x16_bf16 v[200:215], v[176:179], v[16:19], v[200:215]
    v_mfma_f32_32x32x16_bf16 v[200:215], v[180:183], v[20:23], v[200:215]
    buffer_load_dwordx4 v230, s[48:51], s10 offen offset:2048 sc1 lds
    v_mfma_f32_32x32x16_bf16 v[200:215], v[184:187], v[24:27], v[200:215]
    v_mfma_f32_32x32x16_bf16 v[200:215], v[188:191], v[28:31], v[200:215]
    v_mfma_f32_32x32x16_bf16 v[0:15], v[128:131], v[32:35], 0
    buffer_load_dwordx4 v231, s[48:51], s11 offen offset:3072 sc1 lds
    s_add_u32 m0, s44, 12288
    s_nop 0
    v_mfma_f32_32x32x16_bf16 v[0:15], v[132:135], v[36:39], v[0:15]
    v_mfma_f32_32x32x16_bf16 v[0:15], v[136:139], v[40:43], v[0:15]
    v_mfma_f32_32x32x16_bf16 v[0:15], v[140:143], v[44:47], v[0:15]
    buffer_load_dwordx4 v228, s[48:51], s12 offen offset:0 sc1 lds
    v_mfma_f32_32x32x16_bf16 v[0:15], v[176:179], v[48:51], v[0:15]
    v_mfma_f32_32x32x16_bf16 v[0:15], v[180:183], v[52:55], v[0:15]
    v_mfma_f32_32x32x16_bf16 v[0:15], v[184:187], v[56:59], v[0:15]
    buffer_load_dwordx4 v229, s[48:51], s13 offen offset:1024 sc1 lds
    v_mfma_f32_32x32x16_bf16 v[0:15], v[188:191], v[60:63], v[0:15]
    v_mfma_f32_32x32x16_bf16 v[16:31], v[128:131], v[64:67], 0
    v_mfma_f32_32x32x16_bf16 v[16:31], v[132:135], v[68:71], v[16:31]
    buffer_load_dwordx4 v230, s[48:51], s14 offen offset:2048 sc1 lds
    v_mfma_f32_32x32x16_bf16 v[16:31], v[136:139], v[72:75], v[16:31]
    v_mfma_f32_32x32x16_bf16 v[16:31], v[140:143], v[76:79], v[16:31]
    v_mfma_f32_32x32x16_bf16 v[16:31], v[176:179], v[80:83], v[16:31]
    buffer_load_dwordx4 v231, s[48:51], s15 offen offset:3072 sc1 lds
    v_mfma_f32_32x32x16_bf16 v[16:31], v[180:183], v[84:87], v[16:31]
    v_mfma_f32_32x32x16_bf16 v[16:31], v[184:187], v[88:91], v[16:31]
    v_mfma_f32_32x32x16_bf16 v[16:31], v[188:191], v[92:95], v[16:31]
    v_and_or_b32 v232, v232, s45, v241
    buffer_load_dwordx4 v[196:199], v232, s[52:55], 0 offen
    v_mov_b32 v233, 0xbfb8aa3b
    v_mfma_f32_32x32x16_bf16 v[32:47], v[128:131], v[96:99], 0
    v_cvt_pk_bf16_f32 v160, v200, v0
    v_cvt_pk_bf16_f32 v161, v201, v1
    v_cvt_pk_bf16_f32 v162, v202, v2
    v_cvt_pk_bf16_f32 v163, v203, v3
    v_mfma_f32_32x32x16_bf16 v[32:47], v[132:135], v[100:103], v[32:47]
    v_cvt_pk_bf16_f32 v164, v204, v4
    v_cvt_pk_bf16_f32 v165, v205, v5
    v_cvt_pk_bf16_f32 v166, v206, v6
    v_cvt_pk_bf16_f32 v167, v207, v7
    v_mfma_f32_32x32x16_bf16 v[32:47], v[136:139], v[104:107], v[32:47]
    v_cvt_pk_bf16_f32 v168, v208, v8
    v_cvt_pk_bf16_f32 v169, v209, v9
    v_cvt_pk_bf16_f32 v170, v210, v10
    v_cvt_pk_bf16_f32 v171, v211, v11
    v_mfma_f32_32x32x16_bf16 v[32:47], v[140:143], v[108:111], v[32:47]
    v_cvt_pk_bf16_f32 v172, v212, v12
    v_mul_f32 v16, v233, v16
    v_mul_f32 v17, v233, v17
    v_mul_f32 v18, v233, v18
    v_mfma_f32_32x32x16_bf16 v[32:47], v[176:179], v[112:115], v[32:47]
    v_mul_f32 v19, v233, v19
    v_mul_f32 v20, v233, v20
    v_mul_f32 v21, v233, v21
    v_mul_f32 v22, v233, v22
    v_mfma_f32_32x32x16_bf16 v[32:47], v[180:183], v[116:119], v[32:47]
    v_mul_f32 v23, v233, v23
    v_mul_f32 v24, v233, v24
    v_mul_f32 v25, v233, v25
    v_mul_f32 v26, v233, v26
    v_mfma_f32_32x32x16_bf16 v[32:47], v[184:187], v[120:123], v[32:47]
    v_mul_f32 v27, v233, v27
    v_mul_f32 v28, v233, v28
    v_mul_f32 v29, v233, v29
    v_mul_f32 v30, v233, v30
    v_mfma_f32_32x32x16_bf16 v[32:47], v[188:191], v[124:127], v[32:47]
    v_mul_f32 v31, v233, v31
    v_cvt_pk_bf16_f32 v128, v16, v17
    v_cvt_pk_bf16_f32 v129, v18, v19
    v_cvt_pk_bf16_f32 v130, v20, v21
    v_cvt_pk_bf16_f32 v131, v22, v23
    v_cvt_pk_bf16_f32 v132, v24, v25
    v_cvt_pk_bf16_f32 v133, v26, v27
    v_cvt_pk_bf16_f32 v134, v28, v29
    v_cvt_pk_bf16_f32 v135, v30, v31
    v_mov_b32 v208, 0
    v_mov_b32 v209, 0
    v_mov_b32 v210, 0
    v_mov_b32 v211, 0
    v_mul_f32 v32, v233, v32
    v_mul_f32 v33, v233, v33
    v_mul_f32 v34, v233, v34
    v_mul_f32 v35, v233, v35
    v_mfma_f32_32x32x16_bf16 v[0:15], v[208:211], v[208:211], 0
    v_mul_f32 v36, v233, v36
    v_mul_f32 v37, v233, v37
    v_mul_f32 v38, v233, v38
    v_mul_f32 v39, v233, v39
    v_mul_f32 v40, v233, v40
    v_mul_f32 v41, v233, v41
    v_mul_f32 v42, v233, v42
    v_mul_f32 v43, v233, v43
    v_mul_f32 v44, v233, v44
    v_mul_f32 v45, v233, v45
    v_mul_f32 v46, v233, v46
    v_mul_f32 v47, v233, v47
    v_cvt_pk_bf16_f32 v136, v32, v33
    v_cvt_pk_bf16_f32 v137, v34, v35
    v_cvt_pk_bf16_f32 v138, v36, v37
    v_cvt_pk_bf16_f32 v139, v38, v39
    v_cvt_pk_bf16_f32 v140, v40, v41
    v_cvt_pk_bf16_f32 v141, v42, v43
    v_cvt_pk_bf16_f32 v142, v44, v45
    v_cvt_pk_bf16_f32 v143, v46, v47
    v_mfma_f32_32x32x16_bf16 v[32:47], v[208:211], v[208:211], 0
    v_mov_b32 v16, 0x358637bd
    v_mov_b32 v17, v16
    v_mov_b32 v18, v16
    v_mov_b32 v19, v16
    v_mov_b32 v20, v16
    v_mov_b32 v21, v16
    v_mov_b32 v22, v16
    v_mov_b32 v23, v16
    v_mov_b32 v24, v16
    v_mov_b32 v25, v16
    v_mov_b32 v26, v16
    v_mov_b32 v27, v16
    v_mov_b32 v28, v16
    v_mov_b32 v29, v16
    v_mov_b32 v30, v16
    v_mov_b32 v31, v16
    v_mov_b32 v48, v16
    v_mov_b32 v49, v16
    v_mov_b32 v50, v16
    v_mov_b32 v51, v16
    v_mov_b32 v52, v16
    v_mov_b32 v53, v16
    v_mov_b32 v54, v16
    v_mov_b32 v55, v16
    v_mov_b32 v56, v16
    v_mov_b32 v57, v16
    v_mov_b32 v58, v16
    v_mov_b32 v59, v16
    v_mov_b32 v60, v16
    v_mov_b32 v61, v16
    v_mov_b32 v62, v16
    v_mov_b32 v63, v16
    s_cmp_lg_u32 s72, 0
    s_cbranch_scc1 K2_SLOW_INIT
K2_NOU:
    s_cmp_eq_u32 s74, 0
    s_cbranch_scc1 K2_EMPTY
    ds_read_u8 v251, v237 offset:16387
    ds_read2_b32 v[224:225], v236 offset0:64 offset1:72
    ds_read2_b32 v[226:227], v236 offset0:80 offset1:88
    s_waitcnt vmcnt(13) lgkmcnt(0)
    ds_read_b128 v[184:187], v218 offset:0
    ds_read_b128 v[188:191], v219 offset:0
    ds_read_b128 v[176:179], v216 offset:0
    ds_read_b128 v[180:183], v217 offset:0
    v_lshl_add_u32 v233, v251, 4, v242
    ds_read_b128 v[200:203], v233 offset:4096
    ds_read_b32 v204, v233 offset:4112
    v_xor_b32 v224, v224, v240
    v_xor_b32 v225, v225, v240
    v_xor_b32 v226, v226, v240
    v_xor_b32 v227, v227, v240
    s_add_u32 s47, s75, 2
    s_cmp_lt_u32 s47, s74
    s_cselect_b32 s50, 0xc35c00, 0
    s_cselect_b32 s54, 0xc35000, 0
    s_add_u32 m0, s44, 0
    s_waitcnt lgkmcnt(0)
    v_mfma_f32_32x32x16_bf16 v[64:79], v[176:179], v[152:155], 0
    v_mfma_f32_32x32x16_bf16 v[64:79], v[180:183], v[156:159], v[64:79]
    v_mfma_f32_32x32x16_bf16 v[64:79], v[192:195], v[144:147], v[64:79]
    v_smfmac_f32_32x32x32_bf16 v[64:79], v[200:203], v[128:135], v204
    v_mfma_f32_32x32x16_bf16 v[80:95], v[184:187], v[152:155], 0
    v_mfma_f32_32x32x16_bf16 v[80:95], v[188:191], v[156:159], v[80:95]
    buffer_load_dwordx4 v224, s[48:51], s8 offen offset:0 sc1 lds
    buffer_load_dwordx4 v225, s[48:51], s9 offen offset:1024 sc1 lds
    buffer_load_dwordx4 v226, s[48:51], s10 offen offset:2048 sc1 lds
    buffer_load_dwordx4 v227, s[48:51], s11 offen offset:3072 sc1 lds
    s_waitcnt vmcnt(13)
    ds_read_b128 v[184:187], v218 offset:4096
    ds_read_b128 v[188:191], v219 offset:4096
    ds_read_b128 v[176:179], v216 offset:4096
    ds_read_b128 v[180:183], v217 offset:4096
    ds_read2_b32 v[228:229], v236 offset0:96 offset1:104
    ds_read2_b32 v[230:231], v236 offset0:112 offset1:120
    ds_read_b32 v232, v237 offset:16640
    ds_read_u16 v250, v238 offset:24576
    ds_read_u8 v251, v237 offset:16515
    s_add_u32 m0, s44, 4096
    s_waitcnt lgkmcnt(0)
    buffer_load_dwordx4 v224, s[48:51], s12 offen offset:0 sc1 lds
    buffer_load_dwordx4 v225, s[48:51], s13 offen offset:1024 sc1 lds
    s_waitcnt vmcnt(0)
    s_setprio 1
    v_mfma_f32_32x32x16_bf16 v[96:111], v[176:179], v[152:155], 0
    v_exp_f32 v64, v64
    v_exp_f32 v65, v65
    v_exp_f32 v66, v66
    v_mfma_f32_32x32x16_bf16 v[96:111], v[180:183], v[156:159], v[96:111]
    v_exp_f32 v67, v67
    v_exp_f32 v68, v68
    v_exp_f32 v69, v69
    v_mfma_f32_32x32x16_bf16 v[96:111], v[192:195], v[148:151], v[96:111]
    v_exp_f32 v70, v70
    v_exp_f32 v71, v71
    v_exp_f32 v72, v72
    v_smfmac_f32_32x32x32_bf16 v[96:111], v[200:203], v[136:143], v204
    v_exp_f32 v73, v73
    v_exp_f32 v74, v74
    v_exp_f32 v75, v75
    v_exp_f32 v76, v76
    v_exp_f32 v77, v77
    v_exp_f32 v78, v78
    v_exp_f32 v79, v79
    s_setprio 2
    v_add_f32 v64, 1.0, v64
    v_add_f32 v65, 1.0, v65
    v_add_f32 v66, 1.0, v66
    v_add_f32 v67, 1.0, v67
    v_add_f32 v68, 1.0, v68
    v_add_f32 v69, 1.0, v69
    v_add_f32 v70, 1.0, v70
    v_add_f32 v71, 1.0, v71
    v_add_f32 v72, 1.0, v72
    v_add_f32 v73, 1.0, v73
    v_add_f32 v74, 1.0, v74
    v_add_f32 v75, 1.0, v75
    v_add_f32 v76, 1.0, v76
    v_add_f32 v77, 1.0, v77
    v_add_f32 v78, 1.0, v78
    v_add_f32 v79, 1.0, v79
    v_xor_b32 v228, v228, v240
    v_xor_b32 v229, v229, v240
    v_rcp_f32 v64, v64
    v_rcp_f32 v65, v65
    v_rcp_f32 v66, v66
    v_mfma_f32_32x32x16_bf16 v[112:127], v[184:187], v[152:155], 0
    v_rcp_f32 v67, v67
    v_rcp_f32 v68, v68
    v_rcp_f32 v69, v69
    v_mfma_f32_32x32x16_bf16 v[112:127], v[188:191], v[156:159], v[112:127]
    v_rcp_f32 v70, v70
    v_rcp_f32 v71, v71
    v_rcp_f32 v72, v72
    v_rcp_f32 v73, v73
    v_rcp_f32 v74, v74
    v_rcp_f32 v75, v75
    v_rcp_f32 v76, v76
    v_rcp_f32 v77, v77
    v_rcp_f32 v78, v78
    v_rcp_f32 v79, v79
    s_branch K2_LOOP_A
K2_LOOP:
    s_setprio 1
    v_cvt_pk_bf16_f32 v96, v96, v97
    v_cvt_pk_bf16_f32 v97, v98, v99
    v_cvt_pk_bf16_f32 v98, v100, v101
    v_cvt_pk_bf16_f32 v99, v102, v103
    v_cvt_pk_bf16_f32 v100, v104, v105
    v_cvt_pk_bf16_f32 v101, v106, v107
    v_mfma_f32_32x32x16_bf16 v[48:63], v[208:211], v[96:99], v[48:63]
    v_cvt_pk_bf16_f32 v102, v108, v109
    v_cvt_pk_bf16_f32 v103, v110, v111
    v_cvt_pk_bf16_f32 v112, v112, v113
    v_cvt_pk_bf16_f32 v113, v114, v115
    v_cvt_pk_bf16_f32 v114, v116, v117
    v_cvt_pk_bf16_f32 v115, v118, v119
    v_mfma_f32_32x32x16_bf16 v[48:63], v[212:215], v[100:103], v[48:63]
    v_cvt_pk_bf16_f32 v116, v120, v121
    v_cvt_pk_bf16_f32 v117, v122, v123
    v_cvt_pk_bf16_f32 v118, v124, v125
    v_cvt_pk_bf16_f32 v119, v126, v127
    v_exp_f32 v64, v64
    v_mfma_f32_32x32x16_bf16 v[32:47], v[208:211], v[112:115], v[32:47]
    v_exp_f32 v65, v65
    v_exp_f32 v66, v66
    v_exp_f32 v67, v67
    v_mfma_f32_32x32x16_bf16 v[32:47], v[212:215], v[116:119], v[32:47]
    v_exp_f32 v68, v68
    v_exp_f32 v69, v69
    v_exp_f32 v70, v70
    v_mfma_f32_32x32x16_bf16 v[96:111], v[176:179], v[152:155], 0
    v_exp_f32 v71, v71
    v_exp_f32 v72, v72
    v_exp_f32 v73, v73
    v_mfma_f32_32x32x16_bf16 v[96:111], v[180:183], v[156:159], v[96:111]
    v_exp_f32 v74, v74
    v_exp_f32 v75, v75
    v_exp_f32 v76, v76
    v_exp_f32 v77, v77
    v_exp_f32 v78, v78
    v_exp_f32 v79, v79
    s_setprio 2
    v_add_f32 v64, 1.0, v64
    v_add_f32 v65, 1.0, v65
    v_add_f32 v66, 1.0, v66
    v_add_f32 v67, 1.0, v67
    v_add_f32 v68, 1.0, v68
    v_add_f32 v69, 1.0, v69
    v_add_f32 v70, 1.0, v70
    v_add_f32 v71, 1.0, v71
    v_add_f32 v72, 1.0, v72
    v_add_f32 v73, 1.0, v73
    v_add_f32 v74, 1.0, v74
    v_add_f32 v75, 1.0, v75
    v_add_f32 v76, 1.0, v76
    v_add_f32 v77, 1.0, v77
    v_add_f32 v78, 1.0, v78
    v_add_f32 v79, 1.0, v79
    v_xor_b32 v228, v228, v240
    v_xor_b32 v229, v229, v240
    v_mfma_f32_32x32x16_bf16 v[96:111], v[192:195], v[148:151], v[96:111]
    v_rcp_f32 v64, v64
    v_rcp_f32 v65, v65
    v_rcp_f32 v66, v66
    v_smfmac_f32_32x32x32_bf16 v[96:111], v[200:203], v[136:143], v204
    v_rcp_f32 v67, v67
    v_rcp_f32 v68, v68
    v_rcp_f32 v69, v69
    v_rcp_f32 v70, v70
    v_rcp_f32 v71, v71
    v_rcp_f32 v72, v72
    v_mfma_f32_32x32x16_bf16 v[112:127], v[184:187], v[152:155], 0
    v_rcp_f32 v73, v73
    v_rcp_f32 v74, v74
    v_rcp_f32 v75, v75
    v_mfma_f32_32x32x16_bf16 v[112:127], v[188:191], v[156:159], v[112:127]
    v_rcp_f32 v76, v76
    v_rcp_f32 v77, v77
    v_rcp_f32 v78, v78
    v_rcp_f32 v79, v79
    K2_LOOP_A:
    v_lshlrev_b32_sdwa v233, 4, v250 dst_sel:DWORD dst_unused:UNUSED_PAD src0_sel:DWORD src1_sel:BYTE_0
    v_lshlrev_b32_sdwa v234, 4, v250 dst_sel:DWORD dst_unused:UNUSED_PAD src0_sel:DWORD src1_sel:BYTE_1
    v_lshl_add_u32 v235, v251, 4, v242
    v_and_or_b32 v232, v232, s45, v241
    s_setprio 0
    s_waitcnt vmcnt(11)
    ds_read_b128 v[184:187], v218 offset:8192
    ds_read_b128 v[188:191], v219 offset:8192
    ds_read_b128 v[176:179], v216 offset:8192
    ds_read_b128 v[180:183], v217 offset:8192
    buffer_load_dwordx4 v226, s[48:51], s14 offen offset:2048 sc1 lds
    buffer_load_dwordx4 v227, s[48:51], s15 offen offset:3072 sc1 lds
    buffer_load_dwordx4 v[192:195], v232, s[52:55], 0 offen
    ds_read_b128 v[208:211], v233 offset:0
    ds_read_b128 v[212:215], v234 offset:0
    ds_read_b128 v[200:203], v235 offset:4096
    ds_read_b32 v204, v235 offset:4112
    s_add_u32 s47, s75, 3
    s_cmp_lt_u32 s47, s74
    s_cselect_b32 s50, 0xc35c00, 0
    s_cselect_b32 s54, 0xc35000, 0
    s_add_u32 m0, s44, 8192
    v_mul_f32 v80, v80, v64
    v_mul_f32 v81, v81, v65
    v_mul_f32 v82, v82, v66
    v_mul_f32 v83, v83, v67
    v_mul_f32 v84, v84, v68
    v_mul_f32 v85, v85, v69
    v_mul_f32 v86, v86, v70
    v_mul_f32 v87, v87, v71
    v_mul_f32 v88, v88, v72
    v_mul_f32 v89, v89, v73
    v_mul_f32 v90, v90, v74
    v_mul_f32 v91, v91, v75
    v_mul_f32 v92, v92, v76
    v_mul_f32 v93, v93, v77
    v_mul_f32 v94, v94, v78
    v_mul_f32 v95, v95, v79
    s_waitcnt lgkmcnt(0)
    buffer_load_dwordx4 v228, s[48:51], s8 offen offset:0 sc1 lds
    buffer_load_dwordx4 v229, s[48:51], s9 offen offset:1024 sc1 lds
    s_waitcnt vmcnt(11)
    s_cmp_eq_u32 s74, 1
    s_cbranch_scc1 K2_LAST
    s_setprio 1
    v_cvt_pk_bf16_f32 v64, v64, v65
    v_cvt_pk_bf16_f32 v65, v66, v67
    v_cvt_pk_bf16_f32 v66, v68, v69
    v_cvt_pk_bf16_f32 v67, v70, v71
    v_cvt_pk_bf16_f32 v68, v72, v73
    v_cvt_pk_bf16_f32 v69, v74, v75
    v_mfma_f32_32x32x16_bf16 v[16:31], v[208:211], v[64:67], v[16:31]
    v_cvt_pk_bf16_f32 v70, v76, v77
    v_cvt_pk_bf16_f32 v71, v78, v79
    v_cvt_pk_bf16_f32 v80, v80, v81
    v_cvt_pk_bf16_f32 v81, v82, v83
    v_cvt_pk_bf16_f32 v82, v84, v85
    v_cvt_pk_bf16_f32 v83, v86, v87
    v_mfma_f32_32x32x16_bf16 v[16:31], v[212:215], v[68:71], v[16:31]
    s_cmp_lt_u32 s75, s83
    s_cbranch_scc0 K2_B1
    s_barrier
    K2_B1:
    v_cvt_pk_bf16_f32 v84, v88, v89
    v_cvt_pk_bf16_f32 v85, v90, v91
    v_cvt_pk_bf16_f32 v86, v92, v93
    v_cvt_pk_bf16_f32 v87, v94, v95
    v_exp_f32 v96, v96
    v_mfma_f32_32x32x16_bf16 v[0:15], v[208:211], v[80:83], v[0:15]
    v_exp_f32 v97, v97
    v_exp_f32 v98, v98
    v_exp_f32 v99, v99
    v_mfma_f32_32x32x16_bf16 v[0:15], v[212:215], v[84:87], v[0:15]
    v_exp_f32 v100, v100
    v_exp_f32 v101, v101
    v_exp_f32 v102, v102
    v_mfma_f32_32x32x16_bf16 v[64:79], v[176:179], v[152:155], 0
    v_exp_f32 v103, v103
    v_exp_f32 v104, v104
    v_exp_f32 v105, v105
    v_mfma_f32_32x32x16_bf16 v[64:79], v[180:183], v[156:159], v[64:79]
    v_exp_f32 v106, v106
    v_exp_f32 v107, v107
    v_exp_f32 v108, v108
    v_exp_f32 v109, v109
    v_exp_f32 v110, v110
    v_exp_f32 v111, v111
    s_setprio 2
    v_add_f32 v96, 1.0, v96
    v_add_f32 v97, 1.0, v97
    v_add_f32 v98, 1.0, v98
    v_add_f32 v99, 1.0, v99
    v_add_f32 v100, 1.0, v100
    v_add_f32 v101, 1.0, v101
    v_add_f32 v102, 1.0, v102
    v_add_f32 v103, 1.0, v103
    v_add_f32 v104, 1.0, v104
    v_add_f32 v105, 1.0, v105
    v_add_f32 v106, 1.0, v106
    v_add_f32 v107, 1.0, v107
    v_add_f32 v108, 1.0, v108
    v_add_f32 v109, 1.0, v109
    v_add_f32 v110, 1.0, v110
    v_add_f32 v111, 1.0, v111
    v_xor_b32 v230, v230, v240
    v_xor_b32 v231, v231, v240
    v_mfma_f32_32x32x16_bf16 v[64:79], v[196:199], v[144:147], v[64:79]
    v_rcp_f32 v96, v96
    v_rcp_f32 v97, v97
    v_rcp_f32 v98, v98
    v_smfmac_f32_32x32x32_bf16 v[64:79], v[200:203], v[128:135], v204
    v_rcp_f32 v99, v99
    v_rcp_f32 v100, v100
    v_rcp_f32 v101, v101
    v_rcp_f32 v102, v102
    v_rcp_f32 v103, v103
    v_rcp_f32 v104, v104
    v_mfma_f32_32x32x16_bf16 v[80:95], v[184:187], v[152:155], 0
    v_rcp_f32 v105, v105
    v_rcp_f32 v106, v106
    v_rcp_f32 v107, v107
    v_mfma_f32_32x32x16_bf16 v[80:95], v[188:191], v[156:159], v[80:95]
    v_rcp_f32 v108, v108
    v_rcp_f32 v109, v109
    v_rcp_f32 v110, v110
    v_rcp_f32 v111, v111
    s_setprio 0
    ds_read_b128 v[184:187], v218 offset:12288
    ds_read_b128 v[188:191], v219 offset:12288
    ds_read_b128 v[176:179], v216 offset:12288
    ds_read_b128 v[180:183], v217 offset:12288
    s_cmp_lt_u32 s75, s82
    s_cbranch_scc0 K2_B2
    s_barrier
    K2_B2:
    buffer_load_dwordx4 v230, s[48:51], s10 offen offset:2048 sc1 lds
    buffer_load_dwordx4 v231, s[48:51], s11 offen offset:3072 sc1 lds
    ds_read2_b32 v[224:225], v236 offset0:128 offset1:136
    ds_read2_b32 v[226:227], v236 offset0:144 offset1:152
    ds_read_b32 v232, v237 offset:16768
    ds_read_u16 v250, v238 offset:24704
    ds_read_u8 v251, v237 offset:16643
    s_add_u32 m0, s44, 12288
    s_add_u32 s75, s75, 1
    v_mul_f32 v112, v112, v96
    v_mul_f32 v113, v113, v97
    v_mul_f32 v114, v114, v98
    v_mul_f32 v115, v115, v99
    v_mul_f32 v116, v116, v100
    v_mul_f32 v117, v117, v101
    v_mul_f32 v118, v118, v102
    v_mul_f32 v119, v119, v103
    v_mul_f32 v120, v120, v104
    v_mul_f32 v121, v121, v105
    v_mul_f32 v122, v122, v106
    v_mul_f32 v123, v123, v107
    v_mul_f32 v124, v124, v108
    v_mul_f32 v125, v125, v109
    v_mul_f32 v126, v126, v110
    v_mul_f32 v127, v127, v111
    s_waitcnt lgkmcnt(0)
    buffer_load_dwordx4 v228, s[48:51], s12 offen offset:0 sc1 lds
    buffer_load_dwordx4 v229, s[48:51], s13 offen offset:1024 sc1 lds
    s_add_u32 s47, s75, 1
    s_cmp_ge_u32 s47, s74
    s_cbranch_scc1 K2_TAIL1
    s_setprio 1
    v_cvt_pk_bf16_f32 v96, v96, v97
    v_cvt_pk_bf16_f32 v97, v98, v99
    v_cvt_pk_bf16_f32 v98, v100, v101
    v_cvt_pk_bf16_f32 v99, v102, v103
    v_cvt_pk_bf16_f32 v100, v104, v105
    v_cvt_pk_bf16_f32 v101, v106, v107
    v_mfma_f32_32x32x16_bf16 v[48:63], v[208:211], v[96:99], v[48:63]
    v_cvt_pk_bf16_f32 v102, v108, v109
    v_cvt_pk_bf16_f32 v103, v110, v111
    v_cvt_pk_bf16_f32 v112, v112, v113
    v_cvt_pk_bf16_f32 v113, v114, v115
    v_cvt_pk_bf16_f32 v114, v116, v117
    v_cvt_pk_bf16_f32 v115, v118, v119
    v_mfma_f32_32x32x16_bf16 v[48:63], v[212:215], v[100:103], v[48:63]
    v_cvt_pk_bf16_f32 v116, v120, v121
    v_cvt_pk_bf16_f32 v117, v122, v123
    v_cvt_pk_bf16_f32 v118, v124, v125
    v_cvt_pk_bf16_f32 v119, v126, v127
    v_exp_f32 v64, v64
    v_mfma_f32_32x32x16_bf16 v[32:47], v[208:211], v[112:115], v[32:47]
    v_exp_f32 v65, v65
    v_exp_f32 v66, v66
    v_exp_f32 v67, v67
    v_mfma_f32_32x32x16_bf16 v[32:47], v[212:215], v[116:119], v[32:47]
    v_exp_f32 v68, v68
    v_exp_f32 v69, v69
    v_exp_f32 v70, v70
    v_mfma_f32_32x32x16_bf16 v[96:111], v[176:179], v[152:155], 0
    v_exp_f32 v71, v71
    v_exp_f32 v72, v72
    v_exp_f32 v73, v73
    v_mfma_f32_32x32x16_bf16 v[96:111], v[180:183], v[156:159], v[96:111]
    v_exp_f32 v74, v74
    v_exp_f32 v75, v75
    v_exp_f32 v76, v76
    v_exp_f32 v77, v77
    v_exp_f32 v78, v78
    v_exp_f32 v79, v79
    s_setprio 2
    v_add_f32 v64, 1.0, v64
    v_add_f32 v65, 1.0, v65
    v_add_f32 v66, 1.0, v66
    v_add_f32 v67, 1.0, v67
    v_add_f32 v68, 1.0, v68
    v_add_f32 v69, 1.0, v69
    v_add_f32 v70, 1.0, v70
    v_add_f32 v71, 1.0, v71
    v_add_f32 v72, 1.0, v72
    v_add_f32 v73, 1.0, v73
    v_add_f32 v74, 1.0, v74
    v_add_f32 v75, 1.0, v75
    v_add_f32 v76, 1.0, v76
    v_add_f32 v77, 1.0, v77
    v_add_f32 v78, 1.0, v78
    v_add_f32 v79, 1.0, v79
    v_xor_b32 v224, v224, v240
    v_xor_b32 v225, v225, v240
    v_add_u32 v236, 0x100, v236
    v_mfma_f32_32x32x16_bf16 v[96:111], v[196:199], v[148:151], v[96:111]
    v_rcp_f32 v64, v64
    v_rcp_f32 v65, v65
    v_rcp_f32 v66, v66
    v_smfmac_f32_32x32x32_bf16 v[96:111], v[200:203], v[136:143], v204
    v_rcp_f32 v67, v67
    v_rcp_f32 v68, v68
    v_rcp_f32 v69, v69
    v_rcp_f32 v70, v70
    v_rcp_f32 v71, v71
    v_rcp_f32 v72, v72
    v_mfma_f32_32x32x16_bf16 v[112:127], v[184:187], v[152:155], 0
    v_rcp_f32 v73, v73
    v_rcp_f32 v74, v74
    v_rcp_f32 v75, v75
    v_mfma_f32_32x32x16_bf16 v[112:127], v[188:191], v[156:159], v[112:127]
    v_rcp_f32 v76, v76
    v_rcp_f32 v77, v77
    v_rcp_f32 v78, v78
    v_rcp_f32 v79, v79
    v_lshlrev_b32_sdwa v233, 4, v250 dst_sel:DWORD dst_unused:UNUSED_PAD src0_sel:DWORD src1_sel:BYTE_0
    v_lshlrev_b32_sdwa v234, 4, v250 dst_sel:DWORD dst_unused:UNUSED_PAD src0_sel:DWORD src1_sel:BYTE_1
    v_lshl_add_u32 v235, v251, 4, v242
    v_and_or_b32 v232, v232, s45, v241
    s_setprio 0
    s_waitcnt vmcnt(11)
    ds_read_b128 v[184:187], v218 offset:0
    ds_read_b128 v[188:191], v219 offset:0
    ds_read_b128 v[176:179], v216 offset:0
    ds_read_b128 v[180:183], v217 offset:0
    buffer_load_dwordx4 v230, s[48:51], s14 offen offset:2048 sc1 lds
    buffer_load_dwordx4 v231, s[48:51], s15 offen offset:3072 sc1 lds
    buffer_load_dwordx4 v[196:199], v232, s[52:55], 0 offen
    ds_read_b128 v[208:211], v233 offset:0
    ds_read_b128 v[212:215], v234 offset:0
    ds_read_b128 v[200:203], v235 offset:4096
    ds_read_b32 v204, v235 offset:4112
    s_add_u32 s47, s75, 3
    s_cmp_lt_u32 s47, s74
    s_cselect_b32 s50, 0xc35c00, 0
    s_cselect_b32 s54, 0xc35000, 0
    s_add_u32 m0, s44, 0
    v_mul_f32 v80, v80, v64
    v_mul_f32 v81, v81, v65
    v_mul_f32 v82, v82, v66
    v_mul_f32 v83, v83, v67
    v_mul_f32 v84, v84, v68
    v_mul_f32 v85, v85, v69
    v_mul_f32 v86, v86, v70
    v_mul_f32 v87, v87, v71
    v_mul_f32 v88, v88, v72
    v_mul_f32 v89, v89, v73
    v_mul_f32 v90, v90, v74
    v_mul_f32 v91, v91, v75
    v_mul_f32 v92, v92, v76
    v_mul_f32 v93, v93, v77
    v_mul_f32 v94, v94, v78
    v_mul_f32 v95, v95, v79
    s_waitcnt lgkmcnt(0)
    buffer_load_dwordx4 v224, s[48:51], s8 offen offset:0 sc1 lds
    buffer_load_dwordx4 v225, s[48:51], s9 offen offset:1024 sc1 lds
    s_waitcnt vmcnt(11)
    s_setprio 1
    v_cvt_pk_bf16_f32 v64, v64, v65
    v_cvt_pk_bf16_f32 v65, v66, v67
    v_cvt_pk_bf16_f32 v66, v68, v69
    v_cvt_pk_bf16_f32 v67, v70, v71
    v_cvt_pk_bf16_f32 v68, v72, v73
    v_cvt_pk_bf16_f32 v69, v74, v75
    v_mfma_f32_32x32x16_bf16 v[16:31], v[208:211], v[64:67], v[16:31]
    v_cvt_pk_bf16_f32 v70, v76, v77
    v_cvt_pk_bf16_f32 v71, v78, v79
    v_cvt_pk_bf16_f32 v80, v80, v81
    v_cvt_pk_bf16_f32 v81, v82, v83
    v_cvt_pk_bf16_f32 v82, v84, v85
    v_cvt_pk_bf16_f32 v83, v86, v87
    v_mfma_f32_32x32x16_bf16 v[16:31], v[212:215], v[68:71], v[16:31]
    s_cmp_lt_u32 s75, s83
    s_cbranch_scc0 K2_B3
    s_barrier
    K2_B3:
    v_cvt_pk_bf16_f32 v84, v88, v89
    v_cvt_pk_bf16_f32 v85, v90, v91
    v_cvt_pk_bf16_f32 v86, v92, v93
    v_cvt_pk_bf16_f32 v87, v94, v95
    v_exp_f32 v96, v96
    v_mfma_f32_32x32x16_bf16 v[0:15], v[208:211], v[80:83], v[0:15]
    v_exp_f32 v97, v97
    v_exp_f32 v98, v98
    v_exp_f32 v99, v99
    v_mfma_f32_32x32x16_bf16 v[0:15], v[212:215], v[84:87], v[0:15]
    v_exp_f32 v100, v100
    v_exp_f32 v101, v101
    v_exp_f32 v102, v102
    v_mfma_f32_32x32x16_bf16 v[64:79], v[176:179], v[152:155], 0
    v_exp_f32 v103, v103
    v_exp_f32 v104, v104
    v_exp_f32 v105, v105
    v_mfma_f32_32x32x16_bf16 v[64:79], v[180:183], v[156:159], v[64:79]
    v_exp_f32 v106, v106
    v_exp_f32 v107, v107
    v_exp_f32 v108, v108
    v_exp_f32 v109, v109
    v_exp_f32 v110, v110
    v_exp_f32 v111, v111
    s_setprio 2
    v_add_f32 v96, 1.0, v96
    v_add_f32 v97, 1.0, v97
    v_add_f32 v98, 1.0, v98
    v_add_f32 v99, 1.0, v99
    v_add_f32 v100, 1.0, v100
    v_add_f32 v101, 1.0, v101
    v_add_f32 v102, 1.0, v102
    v_add_f32 v103, 1.0, v103
    v_add_f32 v104, 1.0, v104
    v_add_f32 v105, 1.0, v105
    v_add_f32 v106, 1.0, v106
    v_add_f32 v107, 1.0, v107
    v_add_f32 v108, 1.0, v108
    v_add_f32 v109, 1.0, v109
    v_add_f32 v110, 1.0, v110
    v_add_f32 v111, 1.0, v111
    v_xor_b32 v226, v226, v240
    v_xor_b32 v227, v227, v240
    v_add_u32 v237, 0x100, v237
    v_add_u32 v238, 0x100, v238
    v_mfma_f32_32x32x16_bf16 v[64:79], v[192:195], v[144:147], v[64:79]
    v_rcp_f32 v96, v96
    v_rcp_f32 v97, v97
    v_rcp_f32 v98, v98
    v_smfmac_f32_32x32x32_bf16 v[64:79], v[200:203], v[128:135], v204
    v_rcp_f32 v99, v99
    v_rcp_f32 v100, v100
    v_rcp_f32 v101, v101
    v_rcp_f32 v102, v102
    v_rcp_f32 v103, v103
    v_rcp_f32 v104, v104
    v_mfma_f32_32x32x16_bf16 v[80:95], v[184:187], v[152:155], 0
    v_rcp_f32 v105, v105
    v_rcp_f32 v106, v106
    v_rcp_f32 v107, v107
    v_mfma_f32_32x32x16_bf16 v[80:95], v[188:191], v[156:159], v[80:95]
    v_rcp_f32 v108, v108
    v_rcp_f32 v109, v109
    v_rcp_f32 v110, v110
    v_rcp_f32 v111, v111
    s_setprio 0
    ds_read_b128 v[184:187], v218 offset:4096
    ds_read_b128 v[188:191], v219 offset:4096
    ds_read_b128 v[176:179], v216 offset:4096
    ds_read_b128 v[180:183], v217 offset:4096
    s_cmp_lt_u32 s75, s82
    s_cbranch_scc0 K2_B4
    s_barrier
    K2_B4:
    buffer_load_dwordx4 v226, s[48:51], s10 offen offset:2048 sc1 lds
    buffer_load_dwordx4 v227, s[48:51], s11 offen offset:3072 sc1 lds
    ds_read2_b32 v[228:229], v236 offset0:96 offset1:104
    ds_read2_b32 v[230:231], v236 offset0:112 offset1:120
    ds_read_b32 v232, v237 offset:16640
    ds_read_u16 v250, v238 offset:24576
    ds_read_u8 v251, v237 offset:16515
    s_add_u32 m0, s44, 4096
    s_add_u32 s75, s75, 1
    v_mul_f32 v112, v112, v96
    v_mul_f32 v113, v113, v97
    v_mul_f32 v114, v114, v98
    v_mul_f32 v115, v115, v99
    v_mul_f32 v116, v116, v100
    v_mul_f32 v117, v117, v101
    v_mul_f32 v118, v118, v102
    v_mul_f32 v119, v119, v103
    v_mul_f32 v120, v120, v104
    v_mul_f32 v121, v121, v105
    v_mul_f32 v122, v122, v106
    v_mul_f32 v123, v123, v107
    v_mul_f32 v124, v124, v108
    v_mul_f32 v125, v125, v109
    v_mul_f32 v126, v126, v110
    v_mul_f32 v127, v127, v111
    s_waitcnt lgkmcnt(0)
    buffer_load_dwordx4 v224, s[48:51], s12 offen offset:0 sc1 lds
    buffer_load_dwordx4 v225, s[48:51], s13 offen offset:1024 sc1 lds
    s_add_u32 s47, s75, 1
    s_cmp_ge_u32 s47, s74
    s_cbranch_scc1 K2_TAIL0
    s_branch K2_LOOP
K2_TAIL0:
    s_cmp_eq_u32 s36, 0
    s_cbranch_scc1 K2_HALF0
    s_setprio 1
    v_cvt_pk_bf16_f32 v96, v96, v97
    v_cvt_pk_bf16_f32 v97, v98, v99
    v_cvt_pk_bf16_f32 v98, v100, v101
    v_cvt_pk_bf16_f32 v99, v102, v103
    v_cvt_pk_bf16_f32 v100, v104, v105
    v_cvt_pk_bf16_f32 v101, v106, v107
    v_mfma_f32_32x32x16_bf16 v[48:63], v[208:211], v[96:99], v[48:63]
    v_cvt_pk_bf16_f32 v102, v108, v109
    v_cvt_pk_bf16_f32 v103, v110, v111
    v_cvt_pk_bf16_f32 v112, v112, v113
    v_cvt_pk_bf16_f32 v113, v114, v115
    v_cvt_pk_bf16_f32 v114, v116, v117
    v_cvt_pk_bf16_f32 v115, v118, v119
    v_mfma_f32_32x32x16_bf16 v[48:63], v[212:215], v[100:103], v[48:63]
    v_cvt_pk_bf16_f32 v116, v120, v121
    v_cvt_pk_bf16_f32 v117, v122, v123
    v_cvt_pk_bf16_f32 v118, v124, v125
    v_cvt_pk_bf16_f32 v119, v126, v127
    v_exp_f32 v64, v64
    v_mfma_f32_32x32x16_bf16 v[32:47], v[208:211], v[112:115], v[32:47]
    v_exp_f32 v65, v65
    v_exp_f32 v66, v66
    v_exp_f32 v67, v67
    v_mfma_f32_32x32x16_bf16 v[32:47], v[212:215], v[116:119], v[32:47]
    v_exp_f32 v68, v68
    v_exp_f32 v69, v69
    v_exp_f32 v70, v70
    v_mfma_f32_32x32x16_bf16 v[96:111], v[176:179], v[152:155], 0
    v_exp_f32 v71, v71
    v_exp_f32 v72, v72
    v_exp_f32 v73, v73
    v_mfma_f32_32x32x16_bf16 v[96:111], v[180:183], v[156:159], v[96:111]
    v_exp_f32 v74, v74
    v_exp_f32 v75, v75
    v_exp_f32 v76, v76
    v_exp_f32 v77, v77
    v_exp_f32 v78, v78
    v_exp_f32 v79, v79
    s_setprio 2
    v_add_f32 v64, 1.0, v64
    v_add_f32 v65, 1.0, v65
    v_add_f32 v66, 1.0, v66
    v_add_f32 v67, 1.0, v67
    v_add_f32 v68, 1.0, v68
    v_add_f32 v69, 1.0, v69
    v_add_f32 v70, 1.0, v70
    v_add_f32 v71, 1.0, v71
    v_add_f32 v72, 1.0, v72
    v_add_f32 v73, 1.0, v73
    v_add_f32 v74, 1.0, v74
    v_add_f32 v75, 1.0, v75
    v_add_f32 v76, 1.0, v76
    v_add_f32 v77, 1.0, v77
    v_add_f32 v78, 1.0, v78
    v_add_f32 v79, 1.0, v79
    v_mfma_f32_32x32x16_bf16 v[96:111], v[192:195], v[148:151], v[96:111]
    v_rcp_f32 v64, v64
    v_rcp_f32 v65, v65
    v_rcp_f32 v66, v66
    v_smfmac_f32_32x32x32_bf16 v[96:111], v[200:203], v[136:143], v204
    v_rcp_f32 v67, v67
    v_rcp_f32 v68, v68
    v_rcp_f32 v69, v69
    v_rcp_f32 v70, v70
    v_rcp_f32 v71, v71
    v_rcp_f32 v72, v72
    v_mfma_f32_32x32x16_bf16 v[112:127], v[184:187], v[152:155], 0
    v_rcp_f32 v73, v73
    v_rcp_f32 v74, v74
    v_rcp_f32 v75, v75
    v_mfma_f32_32x32x16_bf16 v[112:127], v[188:191], v[156:159], v[112:127]
    v_rcp_f32 v76, v76
    v_rcp_f32 v77, v77
    v_rcp_f32 v78, v78
    v_rcp_f32 v79, v79
    v_lshlrev_b32_sdwa v233, 4, v250 dst_sel:DWORD dst_unused:UNUSED_PAD src0_sel:DWORD src1_sel:BYTE_0
    v_lshlrev_b32_sdwa v234, 4, v250 dst_sel:DWORD dst_unused:UNUSED_PAD src0_sel:DWORD src1_sel:BYTE_1
    s_setprio 0
    ds_read_b128 v[208:211], v233 offset:0
    ds_read_b128 v[212:215], v234 offset:0
    v_mul_f32 v80, v80, v64
    v_mul_f32 v81, v81, v65
    v_mul_f32 v82, v82, v66
    v_mul_f32 v83, v83, v67
    v_mul_f32 v84, v84, v68
    v_mul_f32 v85, v85, v69
    v_mul_f32 v86, v86, v70
    v_mul_f32 v87, v87, v71
    v_mul_f32 v88, v88, v72
    v_mul_f32 v89, v89, v73
    v_mul_f32 v90, v90, v74
    v_mul_f32 v91, v91, v75
    v_mul_f32 v92, v92, v76
    v_mul_f32 v93, v93, v77
    v_mul_f32 v94, v94, v78
    v_mul_f32 v95, v95, v79
    s_waitcnt lgkmcnt(0)
    s_branch K2_LAST
    K2_HALF0:
    s_setprio 1
    v_cvt_pk_bf16_f32 v96, v96, v97
    v_cvt_pk_bf16_f32 v97, v98, v99
    v_cvt_pk_bf16_f32 v98, v100, v101
    v_cvt_pk_bf16_f32 v99, v102, v103
    v_cvt_pk_bf16_f32 v100, v104, v105
    v_cvt_pk_bf16_f32 v101, v106, v107
    v_mfma_f32_32x32x16_bf16 v[48:63], v[208:211], v[96:99], v[48:63]
    v_cvt_pk_bf16_f32 v102, v108, v109
    v_cvt_pk_bf16_f32 v103, v110, v111
    v_cvt_pk_bf16_f32 v112, v112, v113
    v_cvt_pk_bf16_f32 v113, v114, v115
    v_cvt_pk_bf16_f32 v114, v116, v117
    v_cvt_pk_bf16_f32 v115, v118, v119
    v_mfma_f32_32x32x16_bf16 v[48:63], v[212:215], v[100:103], v[48:63]
    v_cvt_pk_bf16_f32 v116, v120, v121
    v_cvt_pk_bf16_f32 v117, v122, v123
    v_cvt_pk_bf16_f32 v118, v124, v125
    v_cvt_pk_bf16_f32 v119, v126, v127
    v_exp_f32 v64, v64
    v_mfma_f32_32x32x16_bf16 v[32:47], v[208:211], v[112:115], v[32:47]
    v_exp_f32 v65, v65
    v_exp_f32 v66, v66
    v_mfma_f32_32x32x16_bf16 v[32:47], v[212:215], v[116:119], v[32:47]
    v_exp_f32 v67, v67
    v_exp_f32 v68, v68
    v_mfma_f32_32x32x16_bf16 v[96:111], v[176:179], v[152:155], 0
    v_exp_f32 v69, v69
    v_exp_f32 v70, v70
    v_mfma_f32_32x32x16_bf16 v[96:111], v[180:183], v[156:159], v[96:111]
    v_exp_f32 v71, v71
    v_add_f32 v64, 1.0, v64
    v_add_f32 v65, 1.0, v65
    v_add_f32 v66, 1.0, v66
    v_add_f32 v67, 1.0, v67
    v_add_f32 v68, 1.0, v68
    v_add_f32 v69, 1.0, v69
    v_add_f32 v70, 1.0, v70
    v_add_f32 v71, 1.0, v71
    s_setprio 2
    v_mfma_f32_32x32x16_bf16 v[96:111], v[192:195], v[148:151], v[96:111]
    v_rcp_f32 v64, v64
    v_rcp_f32 v65, v65
    v_smfmac_f32_32x32x32_bf16 v[96:111], v[200:203], v[136:143], v204
    v_rcp_f32 v66, v66
    v_rcp_f32 v67, v67
    v_rcp_f32 v68, v68
    v_rcp_f32 v69, v69
    v_mfma_f32_32x32x16_bf16 v[112:127], v[184:187], v[152:155], 0
    v_rcp_f32 v70, v70
    v_rcp_f32 v71, v71
    v_mfma_f32_32x32x16_bf16 v[112:127], v[188:191], v[156:159], v[112:127]
    v_lshlrev_b32_sdwa v233, 4, v250 dst_sel:DWORD dst_unused:UNUSED_PAD src0_sel:DWORD src1_sel:BYTE_0
    ds_read_b128 v[208:211], v233 offset:0
    v_mul_f32 v80, v80, v64
    v_mul_f32 v81, v81, v65
    v_mul_f32 v82, v82, v66
    v_mul_f32 v83, v83, v67
    v_mul_f32 v84, v84, v68
    v_mul_f32 v85, v85, v69
    v_mul_f32 v86, v86, v70
    v_mul_f32 v87, v87, v71
    s_waitcnt lgkmcnt(0)
    s_branch K2_HALFB
K2_TAIL1:
    s_cmp_eq_u32 s36, 0
    s_cbranch_scc1 K2_HALF1
    s_setprio 1
    v_cvt_pk_bf16_f32 v96, v96, v97
    v_cvt_pk_bf16_f32 v97, v98, v99
    v_cvt_pk_bf16_f32 v98, v100, v101
    v_cvt_pk_bf16_f32 v99, v102, v103
    v_cvt_pk_bf16_f32 v100, v104, v105
    v_cvt_pk_bf16_f32 v101, v106, v107
    v_mfma_f32_32x32x16_bf16 v[48:63], v[208:211], v[96:99], v[48:63]
    v_cvt_pk_bf16_f32 v102, v108, v109
    v_cvt_pk_bf16_f32 v103, v110, v111
    v_cvt_pk_bf16_f32 v112, v112, v113
    v_cvt_pk_bf16_f32 v113, v114, v115
    v_cvt_pk_bf16_f32 v114, v116, v117
    v_cvt_pk_bf16_f32 v115, v118, v119
    v_mfma_f32_32x32x16_bf16 v[48:63], v[212:215], v[100:103], v[48:63]
    v_cvt_pk_bf16_f32 v116, v120, v121
    v_cvt_pk_bf16_f32 v117, v122, v123
    v_cvt_pk_bf16_f32 v118, v124, v125
    v_cvt_pk_bf16_f32 v119, v126, v127
    v_exp_f32 v64, v64
    v_mfma_f32_32x32x16_bf16 v[32:47], v[208:211], v[112:115], v[32:47]
    v_exp_f32 v65, v65
    v_exp_f32 v66, v66
    v_exp_f32 v67, v67
    v_mfma_f32_32x32x16_bf16 v[32:47], v[212:215], v[116:119], v[32:47]
    v_exp_f32 v68, v68
    v_exp_f32 v69, v69
    v_exp_f32 v70, v70
    v_mfma_f32_32x32x16_bf16 v[96:111], v[176:179], v[152:155], 0
    v_exp_f32 v71, v71
    v_exp_f32 v72, v72
    v_exp_f32 v73, v73
    v_mfma_f32_32x32x16_bf16 v[96:111], v[180:183], v[156:159], v[96:111]
    v_exp_f32 v74, v74
    v_exp_f32 v75, v75
    v_exp_f32 v76, v76
    v_exp_f32 v77, v77
    v_exp_f32 v78, v78
    v_exp_f32 v79, v79
    s_setprio 2
    v_add_f32 v64, 1.0, v64
    v_add_f32 v65, 1.0, v65
    v_add_f32 v66, 1.0, v66
    v_add_f32 v67, 1.0, v67
    v_add_f32 v68, 1.0, v68
    v_add_f32 v69, 1.0, v69
    v_add_f32 v70, 1.0, v70
    v_add_f32 v71, 1.0, v71
    v_add_f32 v72, 1.0, v72
    v_add_f32 v73, 1.0, v73
    v_add_f32 v74, 1.0, v74
    v_add_f32 v75, 1.0, v75
    v_add_f32 v76, 1.0, v76
    v_add_f32 v77, 1.0, v77
    v_add_f32 v78, 1.0, v78
    v_add_f32 v79, 1.0, v79
    v_mfma_f32_32x32x16_bf16 v[96:111], v[196:199], v[148:151], v[96:111]
    v_rcp_f32 v64, v64
    v_rcp_f32 v65, v65
    v_rcp_f32 v66, v66
    v_smfmac_f32_32x32x32_bf16 v[96:111], v[200:203], v[136:143], v204
    v_rcp_f32 v67, v67
    v_rcp_f32 v68, v68
    v_rcp_f32 v69, v69
    v_rcp_f32 v70, v70
    v_rcp_f32 v71, v71
    v_rcp_f32 v72, v72
    v_mfma_f32_32x32x16_bf16 v[112:127], v[184:187], v[152:155], 0
    v_rcp_f32 v73, v73
    v_rcp_f32 v74, v74
    v_rcp_f32 v75, v75
    v_mfma_f32_32x32x16_bf16 v[112:127], v[188:191], v[156:159], v[112:127]
    v_rcp_f32 v76, v76
    v_rcp_f32 v77, v77
    v_rcp_f32 v78, v78
    v_rcp_f32 v79, v79
    v_lshlrev_b32_sdwa v233, 4, v250 dst_sel:DWORD dst_unused:UNUSED_PAD src0_sel:DWORD src1_sel:BYTE_0
    v_lshlrev_b32_sdwa v234, 4, v250 dst_sel:DWORD dst_unused:UNUSED_PAD src0_sel:DWORD src1_sel:BYTE_1
    s_setprio 0
    ds_read_b128 v[208:211], v233 offset:0
    ds_read_b128 v[212:215], v234 offset:0
    v_mul_f32 v80, v80, v64
    v_mul_f32 v81, v81, v65
    v_mul_f32 v82, v82, v66
    v_mul_f32 v83, v83, v67
    v_mul_f32 v84, v84, v68
    v_mul_f32 v85, v85, v69
    v_mul_f32 v86, v86, v70
    v_mul_f32 v87, v87, v71
    v_mul_f32 v88, v88, v72
    v_mul_f32 v89, v89, v73
    v_mul_f32 v90, v90, v74
    v_mul_f32 v91, v91, v75
    v_mul_f32 v92, v92, v76
    v_mul_f32 v93, v93, v77
    v_mul_f32 v94, v94, v78
    v_mul_f32 v95, v95, v79
    s_waitcnt lgkmcnt(0)
    s_branch K2_LAST
    K2_HALF1:
    s_setprio 1
    v_cvt_pk_bf16_f32 v96, v96, v97
    v_cvt_pk_bf16_f32 v97, v98, v99
    v_cvt_pk_bf16_f32 v98, v100, v101
    v_cvt_pk_bf16_f32 v99, v102, v103
    v_cvt_pk_bf16_f32 v100, v104, v105
    v_cvt_pk_bf16_f32 v101, v106, v107
    v_mfma_f32_32x32x16_bf16 v[48:63], v[208:211], v[96:99], v[48:63]
    v_cvt_pk_bf16_f32 v102, v108, v109
    v_cvt_pk_bf16_f32 v103, v110, v111
    v_cvt_pk_bf16_f32 v112, v112, v113
    v_cvt_pk_bf16_f32 v113, v114, v115
    v_cvt_pk_bf16_f32 v114, v116, v117
    v_cvt_pk_bf16_f32 v115, v118, v119
    v_mfma_f32_32x32x16_bf16 v[48:63], v[212:215], v[100:103], v[48:63]
    v_cvt_pk_bf16_f32 v116, v120, v121
    v_cvt_pk_bf16_f32 v117, v122, v123
    v_cvt_pk_bf16_f32 v118, v124, v125
    v_cvt_pk_bf16_f32 v119, v126, v127
    v_exp_f32 v64, v64
    v_mfma_f32_32x32x16_bf16 v[32:47], v[208:211], v[112:115], v[32:47]
    v_exp_f32 v65, v65
    v_exp_f32 v66, v66
    v_mfma_f32_32x32x16_bf16 v[32:47], v[212:215], v[116:119], v[32:47]
    v_exp_f32 v67, v67
    v_exp_f32 v68, v68
    v_mfma_f32_32x32x16_bf16 v[96:111], v[176:179], v[152:155], 0
    v_exp_f32 v69, v69
    v_exp_f32 v70, v70
    v_mfma_f32_32x32x16_bf16 v[96:111], v[180:183], v[156:159], v[96:111]
    v_exp_f32 v71, v71
    v_add_f32 v64, 1.0, v64
    v_add_f32 v65, 1.0, v65
    v_add_f32 v66, 1.0, v66
    v_add_f32 v67, 1.0, v67
    v_add_f32 v68, 1.0, v68
    v_add_f32 v69, 1.0, v69
    v_add_f32 v70, 1.0, v70
    v_add_f32 v71, 1.0, v71
    s_setprio 2
    v_mfma_f32_32x32x16_bf16 v[96:111], v[196:199], v[148:151], v[96:111]
    v_rcp_f32 v64, v64
    v_rcp_f32 v65, v65
    v_smfmac_f32_32x32x32_bf16 v[96:111], v[200:203], v[136:143], v204
    v_rcp_f32 v66, v66
    v_rcp_f32 v67, v67
    v_rcp_f32 v68, v68
    v_rcp_f32 v69, v69
    v_mfma_f32_32x32x16_bf16 v[112:127], v[184:187], v[152:155], 0
    v_rcp_f32 v70, v70
    v_rcp_f32 v71, v71
    v_mfma_f32_32x32x16_bf16 v[112:127], v[188:191], v[156:159], v[112:127]
    v_lshlrev_b32_sdwa v233, 4, v250 dst_sel:DWORD dst_unused:UNUSED_PAD src0_sel:DWORD src1_sel:BYTE_0
    ds_read_b128 v[208:211], v233 offset:0
    v_mul_f32 v80, v80, v64
    v_mul_f32 v81, v81, v65
    v_mul_f32 v82, v82, v66
    v_mul_f32 v83, v83, v67
    v_mul_f32 v84, v84, v68
    v_mul_f32 v85, v85, v69
    v_mul_f32 v86, v86, v70
    v_mul_f32 v87, v87, v71
    s_waitcnt lgkmcnt(0)
K2_HALFB:
    s_setprio 1
    v_cvt_pk_bf16_f32 v64, v64, v65
    v_cvt_pk_bf16_f32 v65, v66, v67
    v_cvt_pk_bf16_f32 v66, v68, v69
    v_cvt_pk_bf16_f32 v67, v70, v71
    v_cvt_pk_bf16_f32 v80, v80, v81
    v_cvt_pk_bf16_f32 v81, v82, v83
    v_cvt_pk_bf16_f32 v82, v84, v85
    v_cvt_pk_bf16_f32 v83, v86, v87
    v_mfma_f32_32x32x16_bf16 v[16:31], v[208:211], v[64:67], v[16:31]
    s_cmp_lt_u32 s75, s83
    s_cbranch_scc0 K2_B5
    s_barrier
    K2_B5:
    v_exp_f32 v96, v96
    v_exp_f32 v97, v97
    v_exp_f32 v98, v98
    v_mfma_f32_32x32x16_bf16 v[0:15], v[208:211], v[80:83], v[0:15]
    v_exp_f32 v99, v99
    v_exp_f32 v100, v100
    v_exp_f32 v101, v101
    v_exp_f32 v102, v102
    v_exp_f32 v103, v103
    v_add_f32 v96, 1.0, v96
    v_add_f32 v97, 1.0, v97
    v_add_f32 v98, 1.0, v98
    v_add_f32 v99, 1.0, v99
    v_add_f32 v100, 1.0, v100
    v_add_f32 v101, 1.0, v101
    v_add_f32 v102, 1.0, v102
    v_add_f32 v103, 1.0, v103
    v_rcp_f32 v96, v96
    v_rcp_f32 v97, v97
    v_rcp_f32 v98, v98
    v_rcp_f32 v99, v99
    v_rcp_f32 v100, v100
    v_rcp_f32 v101, v101
    v_rcp_f32 v102, v102
    v_rcp_f32 v103, v103
    s_cmp_lt_u32 s75, s82
    s_cbranch_scc0 K2_B6
    s_barrier
    K2_B6:
    v_mul_f32 v112, v112, v96
    v_mul_f32 v113, v113, v97
    v_mul_f32 v114, v114, v98
    v_mul_f32 v115, v115, v99
    v_mul_f32 v116, v116, v100
    v_mul_f32 v117, v117, v101
    v_mul_f32 v118, v118, v102
    v_mul_f32 v119, v119, v103
    v_cvt_pk_bf16_f32 v96, v96, v97
    v_cvt_pk_bf16_f32 v97, v98, v99
    v_cvt_pk_bf16_f32 v98, v100, v101
    v_cvt_pk_bf16_f32 v99, v102, v103
    v_cvt_pk_bf16_f32 v112, v112, v113
    v_cvt_pk_bf16_f32 v113, v114, v115
    v_cvt_pk_bf16_f32 v114, v116, v117
    v_cvt_pk_bf16_f32 v115, v118, v119
    v_mfma_f32_32x32x16_bf16 v[48:63], v[208:211], v[96:99], v[48:63]
    s_nop 0
    v_mfma_f32_32x32x16_bf16 v[32:47], v[208:211], v[112:115], v[32:47]
    s_branch K2_PASS_END
K2_LAST:
    s_setprio 1
    v_cvt_pk_bf16_f32 v64, v64, v65
    v_cvt_pk_bf16_f32 v65, v66, v67
    v_cvt_pk_bf16_f32 v66, v68, v69
    v_cvt_pk_bf16_f32 v67, v70, v71
    v_cvt_pk_bf16_f32 v68, v72, v73
    v_cvt_pk_bf16_f32 v69, v74, v75
    v_mfma_f32_32x32x16_bf16 v[16:31], v[208:211], v[64:67], v[16:31]
    v_cvt_pk_bf16_f32 v70, v76, v77
    v_cvt_pk_bf16_f32 v71, v78, v79
    v_cvt_pk_bf16_f32 v80, v80, v81
    v_cvt_pk_bf16_f32 v81, v82, v83
    v_cvt_pk_bf16_f32 v82, v84, v85
    v_cvt_pk_bf16_f32 v83, v86, v87
    v_mfma_f32_32x32x16_bf16 v[16:31], v[212:215], v[68:71], v[16:31]
    s_cmp_lt_u32 s75, s83
    s_cbranch_scc0 K2_B7
    s_barrier
    K2_B7:
    v_cvt_pk_bf16_f32 v84, v88, v89
    v_cvt_pk_bf16_f32 v85, v90, v91
    v_cvt_pk_bf16_f32 v86, v92, v93
    v_cvt_pk_bf16_f32 v87, v94, v95
    v_exp_f32 v96, v96
    v_mfma_f32_32x32x16_bf16 v[0:15], v[208:211], v[80:83], v[0:15]
    v_exp_f32 v97, v97
    v_exp_f32 v98, v98
    v_exp_f32 v99, v99
    v_mfma_f32_32x32x16_bf16 v[0:15], v[212:215], v[84:87], v[0:15]
    v_exp_f32 v100, v100
    v_exp_f32 v101, v101
    v_exp_f32 v102, v102
    v_exp_f32 v103, v103
    v_exp_f32 v104, v104
    v_exp_f32 v105, v105
    v_exp_f32 v106, v106
    v_exp_f32 v107, v107
    v_exp_f32 v108, v108
    v_exp_f32 v109, v109
    v_exp_f32 v110, v110
    v_exp_f32 v111, v111
    s_setprio 2
    v_add_f32 v96, 1.0, v96
    v_add_f32 v97, 1.0, v97
    v_add_f32 v98, 1.0, v98
    v_add_f32 v99, 1.0, v99
    v_add_f32 v100, 1.0, v100
    v_add_f32 v101, 1.0, v101
    v_add_f32 v102, 1.0, v102
    v_add_f32 v103, 1.0, v103
    v_add_f32 v104, 1.0, v104
    v_add_f32 v105, 1.0, v105
    v_add_f32 v106, 1.0, v106
    v_add_f32 v107, 1.0, v107
    v_add_f32 v108, 1.0, v108
    v_add_f32 v109, 1.0, v109
    v_add_f32 v110, 1.0, v110
    v_add_f32 v111, 1.0, v111
    v_rcp_f32 v96, v96
    v_rcp_f32 v97, v97
    v_rcp_f32 v98, v98
    v_rcp_f32 v99, v99
    v_rcp_f32 v100, v100
    v_rcp_f32 v101, v101
    v_rcp_f32 v102, v102
    v_rcp_f32 v103, v103
    v_rcp_f32 v104, v104
    v_rcp_f32 v105, v105
    v_rcp_f32 v106, v106
    v_rcp_f32 v107, v107
    v_rcp_f32 v108, v108
    v_rcp_f32 v109, v109
    v_rcp_f32 v110, v110
    v_rcp_f32 v111, v111
    s_setprio 0
    s_cmp_lt_u32 s75, s82
    s_cbranch_scc0 K2_B8
    s_barrier
    K2_B8:
    v_mul_f32 v112, v112, v96
    v_mul_f32 v113, v113, v97
    v_mul_f32 v114, v114, v98
    v_mul_f32 v115, v115, v99
    v_mul_f32 v116, v116, v100
    v_mul_f32 v117, v117, v101
    v_mul_f32 v118, v118, v102
    v_mul_f32 v119, v119, v103
    v_mul_f32 v120, v120, v104
    v_mul_f32 v121, v121, v105
    v_mul_f32 v122, v122, v106
    v_mul_f32 v123, v123, v107
    v_mul_f32 v124, v124, v108
    v_mul_f32 v125, v125, v109
    v_mul_f32 v126, v126, v110
    v_mul_f32 v127, v127, v111
K2_LOOP_END:
    s_setprio 1
    v_cvt_pk_bf16_f32 v96, v96, v97
    v_cvt_pk_bf16_f32 v97, v98, v99
    v_cvt_pk_bf16_f32 v98, v100, v101
    v_cvt_pk_bf16_f32 v99, v102, v103
    v_cvt_pk_bf16_f32 v100, v104, v105
    v_cvt_pk_bf16_f32 v101, v106, v107
    v_cvt_pk_bf16_f32 v102, v108, v109
    v_cvt_pk_bf16_f32 v103, v110, v111
    v_cvt_pk_bf16_f32 v112, v112, v113
    v_cvt_pk_bf16_f32 v113, v114, v115
    v_cvt_pk_bf16_f32 v114, v116, v117
    v_cvt_pk_bf16_f32 v115, v118, v119
    v_cvt_pk_bf16_f32 v116, v120, v121
    v_cvt_pk_bf16_f32 v117, v122, v123
    v_cvt_pk_bf16_f32 v118, v124, v125
    v_cvt_pk_bf16_f32 v119, v126, v127
    s_nop 1
    v_mfma_f32_32x32x16_bf16 v[48:63], v[208:211], v[96:99], v[48:63]
    v_mfma_f32_32x32x16_bf16 v[32:47], v[208:211], v[112:115], v[32:47]
    v_mfma_f32_32x32x16_bf16 v[32:47], v[212:215], v[116:119], v[32:47]
    v_mfma_f32_32x32x16_bf16 v[48:63], v[212:215], v[100:103], v[48:63]
K2_PASS_END:
    s_cmp_lg_u32 s72, 0
    s_cbranch_scc1 K2_SLOW_NEXT
K2_EPI:
    v_add_u32 v234, 0x1000, v247
    v_rcp_f32 v16, v16
    v_rcp_f32 v17, v17
    v_rcp_f32 v18, v18
    v_rcp_f32 v19, v19
    v_rcp_f32 v20, v20
    v_rcp_f32 v21, v21
    v_rcp_f32 v22, v22
    v_rcp_f32 v23, v23
    v_rcp_f32 v24, v24
    v_rcp_f32 v25, v25
    v_rcp_f32 v26, v26
    v_rcp_f32 v27, v27
    v_rcp_f32 v28, v28
    v_rcp_f32 v48, v48
    v_rcp_f32 v49, v49
    v_rcp_f32 v50, v50
    v_rcp_f32 v51, v51
    v_rcp_f32 v52, v52
    v_rcp_f32 v53, v53
    v_rcp_f32 v54, v54
    v_rcp_f32 v55, v55
    v_rcp_f32 v56, v56
    v_rcp_f32 v57, v57
    v_rcp_f32 v58, v58
    v_rcp_f32 v59, v59
    v_rcp_f32 v60, v60
    v_lshlrev_b32 v64, 16, v160
    v_and_b32 v65, 0xffff0000, v160
    v_fmac_f32 v64, v0, v16
    v_fmac_f32 v65, v32, v48
    v_lshlrev_b32 v66, 16, v220
    v_and_b32 v67, 0xffff0000, v220
    v_max_f32 v64, 0, v64
    v_max_f32 v65, 0, v65
    v_add_f32 v64, v64, v66
    v_add_f32 v65, v65, v67
    v_cvt_pk_bf16_f32 v68, v64, v65
    buffer_store_dword v68, v247, s[68:71], 0 offen offset:0 sc1
    v_lshlrev_b32 v64, 16, v161
    v_and_b32 v65, 0xffff0000, v161
    v_fmac_f32 v64, v1, v17
    v_fmac_f32 v65, v33, v49
    v_lshlrev_b32 v66, 16, v221
    v_and_b32 v67, 0xffff0000, v221
    v_max_f32 v64, 0, v64
    v_max_f32 v65, 0, v65
    v_add_f32 v64, v64, v66
    v_add_f32 v65, v65, v67
    v_cvt_pk_bf16_f32 v69, v64, v65
    buffer_store_dword v69, v247, s[68:71], 0 offen offset:256 sc1
    v_lshlrev_b32 v64, 16, v162
    v_and_b32 v65, 0xffff0000, v162
    v_fmac_f32 v64, v2, v18
    v_fmac_f32 v65, v34, v50
    v_lshlrev_b32 v66, 16, v222
    v_and_b32 v67, 0xffff0000, v222
    v_max_f32 v64, 0, v64
    v_max_f32 v65, 0, v65
    v_add_f32 v64, v64, v66
    v_add_f32 v65, v65, v67
    v_cvt_pk_bf16_f32 v70, v64, v65
    buffer_store_dword v70, v247, s[68:71], 0 offen offset:512 sc1
    v_lshlrev_b32 v64, 16, v163
    v_and_b32 v65, 0xffff0000, v163
    v_fmac_f32 v64, v3, v19
    v_fmac_f32 v65, v35, v51
    v_lshlrev_b32 v66, 16, v223
    v_and_b32 v67, 0xffff0000, v223
    v_max_f32 v64, 0, v64
    v_max_f32 v65, 0, v65
    v_add_f32 v64, v64, v66
    v_add_f32 v65, v65, v67
    v_cvt_pk_bf16_f32 v71, v64, v65
    buffer_store_dword v71, v247, s[68:71], 0 offen offset:768 sc1
    v_lshlrev_b32 v64, 16, v164
    v_and_b32 v65, 0xffff0000, v164
    v_fmac_f32 v64, v4, v20
    v_fmac_f32 v65, v36, v52
    v_lshlrev_b32 v66, 16, v239
    v_and_b32 v67, 0xffff0000, v239
    v_max_f32 v64, 0, v64
    v_max_f32 v65, 0, v65
    v_add_f32 v64, v64, v66
    v_add_f32 v65, v65, v67
    v_cvt_pk_bf16_f32 v72, v64, v65
    buffer_store_dword v72, v247, s[68:71], 0 offen offset:2048 sc1
    v_lshlrev_b32 v64, 16, v165
    v_and_b32 v65, 0xffff0000, v165
    v_fmac_f32 v64, v5, v21
    v_fmac_f32 v65, v37, v53
    v_lshlrev_b32 v66, 16, v252
    v_and_b32 v67, 0xffff0000, v252
    v_max_f32 v64, 0, v64
    v_max_f32 v65, 0, v65
    v_add_f32 v64, v64, v66
    v_add_f32 v65, v65, v67
    v_cvt_pk_bf16_f32 v73, v64, v65
    buffer_store_dword v73, v247, s[68:71], 0 offen offset:2304 sc1
    v_lshlrev_b32 v64, 16, v166
    v_and_b32 v65, 0xffff0000, v166
    v_fmac_f32 v64, v6, v22
    v_fmac_f32 v65, v38, v54
    v_lshlrev_b32 v66, 16, v253
    v_and_b32 v67, 0xffff0000, v253
    v_max_f32 v64, 0, v64
    v_max_f32 v65, 0, v65
    v_add_f32 v64, v64, v66
    v_add_f32 v65, v65, v67
    v_cvt_pk_bf16_f32 v74, v64, v65
    buffer_store_dword v74, v247, s[68:71], 0 offen offset:2560 sc1
    v_lshlrev_b32 v64, 16, v167
    v_and_b32 v65, 0xffff0000, v167
    v_fmac_f32 v64, v7, v23
    v_fmac_f32 v65, v39, v55
    v_lshlrev_b32 v66, 16, v254
    v_and_b32 v67, 0xffff0000, v254
    v_max_f32 v64, 0, v64
    v_max_f32 v65, 0, v65
    v_add_f32 v64, v64, v66
    v_add_f32 v65, v65, v67
    v_cvt_pk_bf16_f32 v75, v64, v65
    buffer_store_dword v75, v247, s[68:71], 0 offen offset:2816 sc1
    v_lshlrev_b32 v64, 16, v168
    v_and_b32 v65, 0xffff0000, v168
    v_fmac_f32 v64, v8, v24
    v_fmac_f32 v65, v40, v56
    v_lshlrev_b32 v66, 16, v255
    v_and_b32 v67, 0xffff0000, v255
    v_max_f32 v64, 0, v64
    v_max_f32 v65, 0, v65
    v_add_f32 v64, v64, v66
    v_add_f32 v65, v65, v67
    v_cvt_pk_bf16_f32 v76, v64, v65
    buffer_store_dword v76, v234, s[68:71], 0 offen offset:0 sc1
    v_lshlrev_b32 v64, 16, v169
    v_and_b32 v65, 0xffff0000, v169
    v_fmac_f32 v64, v9, v25
    v_fmac_f32 v65, v41, v57
    v_lshlrev_b32 v66, 16, v173
    v_and_b32 v67, 0xffff0000, v173
    v_max_f32 v64, 0, v64
    v_max_f32 v65, 0, v65
    v_add_f32 v64, v64, v66
    v_add_f32 v65, v65, v67
    v_cvt_pk_bf16_f32 v77, v64, v65
    buffer_store_dword v77, v234, s[68:71], 0 offen offset:256 sc1
    v_lshlrev_b32 v64, 16, v170
    v_and_b32 v65, 0xffff0000, v170
    v_fmac_f32 v64, v10, v26
    v_fmac_f32 v65, v42, v58
    v_lshlrev_b32 v66, 16, v174
    v_and_b32 v67, 0xffff0000, v174
    v_max_f32 v64, 0, v64
    v_max_f32 v65, 0, v65
    v_add_f32 v64, v64, v66
    v_add_f32 v65, v65, v67
    v_cvt_pk_bf16_f32 v78, v64, v65
    buffer_store_dword v78, v234, s[68:71], 0 offen offset:512 sc1
    v_lshlrev_b32 v64, 16, v171
    v_and_b32 v65, 0xffff0000, v171
    v_fmac_f32 v64, v11, v27
    v_fmac_f32 v65, v43, v59
    v_lshlrev_b32 v66, 16, v175
    v_and_b32 v67, 0xffff0000, v175
    v_max_f32 v64, 0, v64
    v_max_f32 v65, 0, v65
    v_add_f32 v64, v64, v66
    v_add_f32 v65, v65, v67
    v_cvt_pk_bf16_f32 v79, v64, v65
    buffer_store_dword v79, v234, s[68:71], 0 offen offset:768 sc1
    v_lshlrev_b32 v64, 16, v172
    v_and_b32 v65, 0xffff0000, v172
    v_fmac_f32 v64, v12, v28
    v_fmac_f32 v65, v44, v60
    v_lshlrev_b32 v66, 16, v243
    v_and_b32 v67, 0xffff0000, v243
    v_max_f32 v64, 0, v64
    v_max_f32 v65, 0, v65
    v_add_f32 v64, v64, v66
    v_add_f32 v65, v65, v67
    v_cvt_pk_bf16_f32 v80, v64, v65
    s_mov_b32 exec_hi, 0
    s_mov_b32 exec_lo, s101
    buffer_store_dword v80, v234, s[68:71], 0 offen offset:2048 sc1
    s_endpgm
K2_EMPTY:
    s_waitcnt vmcnt(0)
    s_branch K2_PASS_END
K2_SLOW_INIT:
    s_lshl_b32 s26, s25, 4
    s_add_u32 s26, s26, 0x1c0000
    s_mov_b32 s84, 0
    s_mov_b32 s85, 0
    s_branch K2_SLOW_PASS
K2_SLOW_NEXT:
    s_add_u32 s85, s85, 256
K2_SLOW_PASS:
    s_cmp_ge_u32 s84, 250
    s_cbranch_scc1 K2_SLOW_END
    s_lshl_b32 s47, s84, 12
    s_add_u32 s47, s47, s26
    s_buffer_load_dwordx4 s[88:91], s[28:31], s47 glc
    s_waitcnt lgkmcnt(0)
    s_max_u32 s86, s88, s90
    s_lshr_b32 s86, s86, 16
    s_cmp_lt_u32 s85, s86
    s_cbranch_scc1 K2_SLOW_GO
    s_add_u32 s84, s84, 1
    s_mov_b32 s85, 0
    s_branch K2_SLOW_PASS
K2_SLOW_GO:
    s_waitcnt vmcnt(0) lgkmcnt(0)
    s_nop 7
    s_barrier
    v_lshlrev_b32 v64, 4, v248
    v_mov_b32 v68, 0x80000000
    v_mov_b32 v69, v68
    v_mov_b32 v70, v68
    v_mov_b32 v71, v68
    ds_write_b128 v64, v[68:71] offset:8192
    v_mov_b32 v72, 0x7cffffe0
    v_mov_b32 v73, v72
    v_mov_b32 v74, v72
    v_mov_b32 v75, v72
    ds_write_b128 v64, v[72:75] offset:16384
    v_mov_b32 v76, 0
    v_mov_b32 v77, 0
    v_mov_b32 v78, 0
    v_mov_b32 v79, 0
    ds_write_b128 v64, v[76:79] offset:24576
    v_lshlrev_b32 v65, 2, v248
    ds_write_b32 v65, v76 offset:6144
    v_mov_b32 v66, s88
    s_mov_b32 exec_lo, 0xaaaaaaaa
    s_mov_b32 exec_hi, 0xaaaaaaaa
    v_mov_b32 v66, s90
    s_mov_b64 exec, -1
    v_lshrrev_b32 v67, 1, v248
    v_add_u32 v67, s85, v67
    v_lshrrev_b32 v80, 16, v66
    v_and_b32 v66, 0xffff, v66
    v_cmp_lt_u32 vcc, v67, v80
    v_add_u32 v66, v66, v67
    v_lshlrev_b32 v66, 2, v66
    v_cndmask_b32 v249, 0, 1, vcc
    s_mul_i32 s47, s84, 6400
    buffer_load_dword v96, v66, s[28:31], s47 offen sc1
    s_lshl_b32 s47, s84, 1
    v_and_b32 v67, 1, v248
    v_add_u32 v106, s47, v67
    s_waitcnt vmcnt(0) lgkmcnt(0)
    s_barrier
    v_mov_b32 v116, 1
    s_mov_b32 s43, 10736
    s_movk_i32 s47, 25600
    v_mov_b32 v64, 0
    s_waitcnt lgkmcnt(0)
    v_cmpx_lt_i32 vcc, 0, v249
    v_mul_hi_u32 v64, s43, v96
    v_bfe_u32 v64, v64, 8, 5
    v_and_or_b32 v64, v96, 32, v64
    v_and_b32 v117, 1, v106
    v_lshl_or_b32 v64, v117, 6, v64
    v_lshlrev_b32 v64, 2, v64
    ds_add_rtn_u32 v74, v64, v116 offset:6144
    v_sub_u32 v117, v106, v117
    v_bfe_u32 v118, v96, 6, 11
    v_lshlrev_b32 v118, 5, v118
    v_mad_u32_u24 v117, v117, s47, v118
    v_and_b32 v118, 31, v96
    v_lshl_or_b32 v84, v118, 26, v117
    v_lshrrev_b32 v106, 17, v96
    K2_HS:
    s_mov_b64 exec, -1
    v_and_b32 v119, 63, v248
    v_lshlrev_b32 v119, 3, v119
    v_mov_b32 v124, 0
    s_waitcnt lgkmcnt(0)
    s_barrier
    ds_read_b64 v[120:121], v119 offset:6144
    ds_read_b32 v124, v124 offset:7168
    s_waitcnt lgkmcnt(0)
    v_add_u32 v122, v120, v121
    v_mov_b32 v123, v122
    s_nop 1
    v_add_u32_dpp v123, v123, v123 row_shr:1 row_mask:0xf bank_mask:0xf bound_ctrl:0
    s_nop 1
    v_add_u32_dpp v123, v123, v123 row_shr:2 row_mask:0xf bank_mask:0xf bound_ctrl:0
    s_nop 1
    v_add_u32_dpp v123, v123, v123 row_shr:4 row_mask:0xf bank_mask:0xf bound_ctrl:0
    s_nop 1
    v_add_u32_dpp v123, v123, v123 row_shr:8 row_mask:0xf bank_mask:0xf bound_ctrl:0
    v_readfirstlane_b32 s73, v124
    v_readlane_b32 s74, v123, 15
    v_readlane_b32 s75, v123, 31
    v_readlane_b32 s76, v123, 47
    v_readlane_b32 s77, v123, 63
    v_sub_u32 v124, v123, v122
    s_cmp_eq_u32 s66, 1
    s_cselect_b32 s36, s75, s74
    s_cmp_eq_u32 s66, 2
    s_cselect_b32 s36, s76, s36
    s_cmp_eq_u32 s66, 3
    s_cselect_b32 s36, s77, s36
    s_sub_u32 s36, s36, 1
    s_and_b32 s36, s36, 16
    s_add_u32 s74, s74, 31
    s_and_b32 s74, s74, 0xffffffe0
    s_add_u32 s75, s75, 31
    s_and_b32 s75, s75, 0xffffffe0
    s_add_u32 s76, s76, 31
    s_and_b32 s76, s76, 0xffffffe0
    s_add_u32 s77, s77, 31
    s_and_b32 s77, s77, 0xffffffe0
    s_mov_b32 s78, 0
    s_add_u32 s80, s74, s75
    s_add_u32 s81, s80, s76
    s_add_u32 s82, s81, s77
    s_mov_b32 exec_lo, 0xffff0000
    s_mov_b32 exec_hi, 0
    v_add_u32 v124, s74, v124
    s_mov_b32 exec_lo, 0
    s_mov_b32 exec_hi, 0xffff
    v_add_u32 v124, s80, v124
    s_mov_b32 exec_hi, 0xffff0000
    v_add_u32 v124, s81, v124
    s_mov_b64 exec, -1
    v_add_u32 v125, v124, v120
    ds_write_b64 v119, v[124:125] offset:6656
    ds_read_b32 v64, v64 offset:6656
    s_cmp_gt_u32 s82, 2048
    s_cselect_b32 s73, 1, s73
    s_min_u32 s82, s74, s75
    s_min_u32 s83, s76, s77
    s_min_u32 s82, s82, s83
    s_lshr_b32 s82, s82, 5
    s_cmp_lt_u32 s24, 4
    s_cselect_b32 s83, 0, s82
    s_cselect_b32 s82, s82, 0
    s_cmp_eq_u32 s66, 1
    s_cselect_b32 s78, s74, s78
    s_cselect_b32 s74, s75, s74
    s_cmp_eq_u32 s66, 2
    s_cselect_b32 s74, s76, s74
    s_cselect_b32 s78, s80, s78
    s_cmp_eq_u32 s66, 3
    s_cselect_b32 s74, s77, s74
    s_cselect_b32 s78, s81, s78
    s_lshr_b32 s74, s74, 5
    s_lshl_b32 s47, s78, 2
    v_add_u32 v236, s47, v244
    v_add_u32 v237, s47, v245
    v_add_u32 v238, s47, v246
    s_mov_b32 s75, 0
    s_waitcnt lgkmcnt(0)
    v_cmpx_lt_i32 vcc, 0, v249
    v_add_u32 v64, v64, v74
    v_lshlrev_b32 v120, 2, v64
    v_bfe_u32 v122, v64, 1, 3
    v_lshl_or_b32 v121, v106, 3, v122
    v_lshlrev_b32 v121, 4, v121
    ds_write2st64_b32 v120, v121, v84 offset0:32 offset1:64
    v_bfi_b32 v123, 31, v96, v64
    v_lshlrev_b32 v123, 2, v123
    v_and_b32 v124, 4, v64
    v_lshrrev_b32 v125, 1, v64
    v_bfi_b32 v125, 3, v64, v125
    v_lshlrev_b32 v124, 2, v124
    v_bfi_b32 v124, 15, v125, v124
    v_lshlrev_b32 v124, v124, v116
    ds_or_b32 v123, v124 offset:24576
    K2_SS:
    s_mov_b64 exec, -1
    s_waitcnt lgkmcnt(0)
    s_barrier
    ds_read2_b32 v[224:225], v236 offset0:0 offset1:8
    ds_read2_b32 v[226:227], v236 offset0:16 offset1:24
    ds_read_b32 v232, v237 offset:16384
    ds_read2_b32 v[228:229], v236 offset0:32 offset1:40
    ds_read2_b32 v[230:231], v236 offset0:48 offset1:56
    s_add_u32 s47, s75, 0
    s_cmp_lt_u32 s47, s74
    s_cselect_b32 s50, 0xc35c00, 0
    s_cselect_b32 s54, 0xc35000, 0
    s_add_u32 m0, s44, 0
    s_waitcnt lgkmcnt(0)
    v_xor_b32 v224, v224, v240
    v_xor_b32 v225, v225, v240
    v_xor_b32 v226, v226, v240
    v_xor_b32 v227, v227, v240
    buffer_load_dwordx4 v224, s[48:51], s8 offen offset:0 sc1 lds
    buffer_load_dwordx4 v225, s[48:51], s9 offen offset:1024 sc1 lds
    buffer_load_dwordx4 v226, s[48:51], s10 offen offset:2048 sc1 lds
    buffer_load_dwordx4 v227, s[48:51], s11 offen offset:3072 sc1 lds
    v_and_or_b32 v232, v232, s45, v241
    buffer_load_dwordx4 v[192:195], v232, s[52:55], 0 offen
    ds_read_b32 v232, v237 offset:16512
    s_add_u32 m0, s44, 4096
    v_xor_b32 v228, v228, v240
    v_xor_b32 v229, v229, v240
    v_xor_b32 v230, v230, v240
    v_xor_b32 v231, v231, v240
    buffer_load_dwordx4 v224, s[48:51], s12 offen offset:0 sc1 lds
    buffer_load_dwordx4 v225, s[48:51], s13 offen offset:1024 sc1 lds
    buffer_load_dwordx4 v226, s[48:51], s14 offen offset:2048 sc1 lds
    buffer_load_dwordx4 v227, s[48:51], s15 offen offset:3072 sc1 lds
    s_add_u32 s47, s75, 1
    s_cmp_lt_u32 s47, s74
    s_cselect_b32 s50, 0xc35c00, 0
    s_cselect_b32 s54, 0xc35000, 0
    s_add_u32 m0, s44, 8192
    s_waitcnt lgkmcnt(0)
    buffer_load_dwordx4 v228, s[48:51], s8 offen offset:0 sc1 lds
    buffer_load_dwordx4 v229, s[48:51], s9 offen offset:1024 sc1 lds
    buffer_load_dwordx4 v230, s[48:51], s10 offen offset:2048 sc1 lds
    buffer_load_dwordx4 v231, s[48:51], s11 offen offset:3072 sc1 lds
    s_add_u32 m0, s44, 12288
    s_nop 0
    buffer_load_dwordx4 v228, s[48:51], s12 offen offset:0 sc1 lds
    buffer_load_dwordx4 v229, s[48:51], s13 offen offset:1024 sc1 lds
    buffer_load_dwordx4 v230, s[48:51], s14 offen offset:2048 sc1 lds
    buffer_load_dwordx4 v231, s[48:51], s15 offen offset:3072 sc1 lds
    v_and_or_b32 v232, v232, s45, v241
    buffer_load_dwordx4 v[196:199], v232, s[52:55], 0 offen
    s_branch K2_NOU
K2_SLOW_END:
    s_waitcnt vmcnt(0)
    s_branch K2_EPI
K1_WPREP:
    s_mov_b32 s42, 0x05040100
    s_mov_b32 s43, 0x07060302
    s_cmp_ge_u32 s2, 254
    s_waitcnt vmcnt(0)
    s_cbranch_scc1 K1_WC
    v_perm_b32 v80, v65, v64, s42
    v_perm_b32 v81, v67, v66, s42
    v_perm_b32 v82, v69, v68, s42
    v_perm_b32 v83, v71, v70, s42
    v_perm_b32 v84, v65, v64, s43
    v_perm_b32 v85, v67, v66, s43
    v_perm_b32 v86, v69, v68, s43
    v_perm_b32 v87, v71, v70, s43
    v_perm_b32 v88, v73, v72, s42
    v_perm_b32 v89, v75, v74, s42
    v_perm_b32 v90, v77, v76, s42
    v_perm_b32 v91, v79, v78, s42
    v_perm_b32 v92, v73, v72, s43
    v_perm_b32 v93, v75, v74, s43
    v_perm_b32 v94, v77, v76, s43
    v_perm_b32 v95, v79, v78, s43
    s_sub_u32 s47, s2, 250
    s_lshl_b32 s47, s47, 14
    s_lshl_b32 s41, s24, 11
    s_add_u32 s47, s47, s41
    s_add_u32 s47, s47, 0x300000
    s_add_u32 s41, s47, 8192
    buffer_store_dwordx4 v[80:83], v210, s[28:31], s47 offen offset:0 sc1
    buffer_store_dwordx4 v[84:87], v210, s[28:31], s41 offen offset:0 sc1
    buffer_store_dwordx4 v[88:91], v210, s[28:31], s47 offen offset:1024 sc1
    buffer_store_dwordx4 v[92:95], v210, s[28:31], s41 offen offset:1024 sc1
    s_branch K1_WDONE
K1_WC:
    v_mov_b32 v13, 0xbfb8aa3b
    v_lshlrev_b32 v80, 16, v64
    v_and_b32 v88, 0xffff0000, v64
    v_mul_f32 v80, v13, v80
    v_mul_f32 v88, v13, v88
    v_lshlrev_b32 v81, 16, v65
    v_and_b32 v89, 0xffff0000, v65
    v_mul_f32 v81, v13, v81
    v_mul_f32 v89, v13, v89
    v_lshlrev_b32 v82, 16, v66
    v_and_b32 v90, 0xffff0000, v66
    v_mul_f32 v82, v13, v82
    v_mul_f32 v90, v13, v90
    v_lshlrev_b32 v83, 16, v67
    v_and_b32 v91, 0xffff0000, v67
    v_mul_f32 v83, v13, v83
    v_mul_f32 v91, v13, v91
    v_lshlrev_b32 v84, 16, v68
    v_and_b32 v92, 0xffff0000, v68
    v_mul_f32 v84, v13, v84
    v_mul_f32 v92, v13, v92
    v_lshlrev_b32 v85, 16, v69
    v_and_b32 v93, 0xffff0000, v69
    v_mul_f32 v85, v13, v85
    v_mul_f32 v93, v13, v93
    v_lshlrev_b32 v86, 16, v70
    v_and_b32 v94, 0xffff0000, v70
    v_mul_f32 v86, v13, v86
    v_mul_f32 v94, v13, v94
    v_lshlrev_b32 v87, 16, v71
    v_and_b32 v95, 0xffff0000, v71
    v_mul_f32 v87, v13, v87
    v_mul_f32 v95, v13, v95
    v_cvt_pk_bf16_f32 v64, v80, v81
    v_cvt_pk_bf16_f32 v65, v82, v83
    v_cvt_pk_bf16_f32 v66, v84, v85
    v_cvt_pk_bf16_f32 v67, v86, v87
    v_cvt_pk_bf16_f32 v68, v88, v89
    v_cvt_pk_bf16_f32 v69, v90, v91
    v_cvt_pk_bf16_f32 v70, v92, v93
    v_cvt_pk_bf16_f32 v71, v94, v95
    s_and_b32 s47, s2, 1
    s_lshl_b32 s47, s47, 11
    s_add_u32 s47, s47, 0x318000
    buffer_store_dwordx4 v[64:67], v210, s[28:31], s47 offen sc1
    buffer_store_dwordx4 v[68:71], v210, s[28:31], s47 offen offset:1024 sc1
K1_WDONE:
    v_mov_b32 v96, 0
    v_mov_b32 v97, s79
    v_mov_b32 v98, 0
    v_mov_b32 v99, s79
    s_lshl_b32 s47, s2, 12
    s_add_u32 s47, s47, 0x1c0000
    v_mov_b32 v100, 1
    s_mov_b64 exec, 1
    s_waitcnt vmcnt(0)
    ds_add_rtn_u32 v100, v96, v100 offset:7192
    s_waitcnt lgkmcnt(0)
    v_cmp_eq_u32 vcc, 3, v100
    s_mov_b64 exec, -1
    s_cbranch_vccz K1_PUBD
    buffer_store_dwordx4 v[96:99], v210, s[28:31], s47 offen offset:0 sc1
    buffer_store_dwordx4 v[96:99], v210, s[28:31], s47 offen offset:1024 sc1
    buffer_store_dwordx4 v[96:99], v210, s[28:31], s47 offen offset:2048 sc1
    buffer_store_dwordx4 v[96:99], v210, s[28:31], s47 offen offset:3072 sc1
    s_branch K1_PUBA
K2_END:
    s_endpgm
.section .rodata,"a"
.p2align 6
.amdhsa_kernel standalone__edge_featured_mpnn_gatedgcn__graph_kernel
  .amdhsa_next_free_vgpr 256
  .amdhsa_next_free_sgpr 102
  .amdhsa_accum_offset 256
  .amdhsa_group_segment_fixed_size 0
  .amdhsa_kernarg_size 96
  .amdhsa_user_sgpr_count 2
  .amdhsa_user_sgpr_kernarg_segment_ptr 1
  .amdhsa_system_sgpr_workgroup_id_x 1
.end_amdhsa_kernel
```
